```python
import torch

def _softmax(x, axis=-1):
    return torch.softmax(x, dim=axis)
def _gelu(x):
    return torch.nn.functional.gelu(x, approximate="tanh")
def _silu(x):
    return torch.nn.functional.silu(x)
def _sigmoid(x):
    return torch.sigmoid(x)
def _layernorm(x, axis=-1, eps=1e-5):
    m = x.mean(dim=axis, keepdim=True)
    v = x.var(dim=axis, keepdim=True, unbiased=False)
    return (x - m) / torch.sqrt(v + eps)
def _scatter_add(tgt, idx, src, axis=0):
    return tgt.clone().index_add_(axis, idx, src)
def _segment_sum(src, seg, n):
    out = torch.zeros((n,) + src.shape[1:], dtype=src.dtype)
    return out.index_add_(0, seg, src)
def _pad(x, pw):
    flat = tuple(v for pair in reversed(pw) for v in pair)
    return torch.nn.functional.pad(x, flat)

kernel_name = 'parallel_sum__linear_kernel_hedgehog__dense_activation_relu__prompt'

def setup_inputs():

    _w = (lambda a: (lambda t: t.to(torch.bfloat16) if t.is_floating_point() else t)(torch.as_tensor(a)))
    def _A_setup():
        B, S, D, H = 1, 2048, 640, 32
        Dh = D // H
        return {
            "x": _w((lambda *s: torch.randn(*s, dtype=torch.bfloat16) * 0.05)(B, S, D)),
            "wqkv": _w((lambda *s: torch.randn(*s, dtype=torch.bfloat16) * 0.4)(D, 3 * D)),
            "w_phi": _w((lambda *s: torch.randn(*s, dtype=torch.bfloat16) * 0.4)(H, Dh, Dh) * (Dh ** -0.5)),
            "wo": _w((lambda *s: torch.randn(*s, dtype=torch.bfloat16) * 0.1)(D, D)),
        }
    _A_in = _A_setup()

    def _B_setup():
        B, S, D, Dff = 1, 2048, 640, 1728
        return {
            "x": _w((lambda *s: torch.randn(*s, dtype=torch.bfloat16) * 0.05)(B, S, D)),
            "w1": _w((lambda *s: torch.randn(*s, dtype=torch.bfloat16) * 0.05)(D, Dff)),
            "w2": _w((lambda *s: torch.randn(*s, dtype=torch.bfloat16) * 0.05)(Dff, D)),
        }
    _B_in = _B_setup()

    return {
        "A_x": _A_in["x"],
        "A_wqkv": _A_in["wqkv"],
        "A_w_phi": _A_in["w_phi"],
        "A_wo": _A_in["wo"],
        "B_x": _B_in["x"],
        "B_w1": _B_in["w1"],
        "B_w2": _B_in["w2"],
    }

def reference(A_x, A_wqkv, A_w_phi, A_wo, B_x, B_w1, B_w2):
    def _A_ref(x, wqkv, w_phi, wo):
        B, S, D = x.shape
        H = 32; Dh = D // H
        qkv = (lambda x, *d: x.permute(*d))((x @ wqkv).reshape(B, S, 3, H, Dh), 2, 0, 3, 1, 4)
        q, k, v = qkv[0], qkv[1], qkv[2]
        pq = torch.einsum("bhsd,hdf->bhsf", q, w_phi)
        pk = torch.einsum("bhsd,hdf->bhsf", k, w_phi)
        phi_q = torch.concatenate([_softmax(pq, axis=-1), _softmax(-pq, axis=-1)], axis=-1)
        phi_k = torch.concatenate([_softmax(pk, axis=-1), _softmax(-pk, axis=-1)], axis=-1)
        kv = torch.einsum("bhsf,bhsd->bhfd", phi_k, v)
        z  = torch.einsum("bhsf->bhf", phi_k)
        num = torch.einsum("bhqf,bhfd->bhqd", phi_q, kv)
        den = torch.einsum("bhqf,bhf->bhq", phi_q, z)[..., None] + 1e-6
        o = num / den
        return (lambda x, *d: x.permute(*d))(o, 0, 2, 1, 3).reshape(B, S, D) @ wo

    def _B_ref(x, w1, w2):
        h = torch.einsum("bsd,df->bsf", x, w1)
        zero = torch.zeros_like(h)
        h = torch.maximum(h, zero)
        return torch.einsum("bsf,fd->bsd", h, w2)

    x = A_x
    xn = _layernorm(x, axis=-1)
    return x + _A_ref(xn, A_wqkv, A_w_phi, A_wo) + _B_ref(xn, B_w1, B_w2)
```

```asm
; @launch kernel=hh1_kernel grid=(256,1,1) block=(512,1,1) lds=163840
; @launch kernel=hh2_kernel grid=(256,1,1) block=(512,1,1) lds=87104
.amdgcn_target "amdgcn-amd-amdhsa--gfx950"
.text
.globl hh1_kernel
.p2align 8
.type hh1_kernel,@function
hh1_kernel:
    s_cmp_ge_u32 s2, 256
    s_cbranch_scc1 K1_EXIT
    s_load_dwordx8 s[8:15], s[0:1], 0
    s_load_dwordx4 s[16:19], s[0:1], 40
    s_load_dwordx4 s[20:23], s[0:1], 64
    s_cmp_lt_u32 s2, 8
    s_cbranch_scc0 K1_NOCPF
    s_getpc_b64 s[24:25]
K1_PCREF:
    v_lshlrev_b32 v4, 7, v0
    s_mov_b32 s26, (HH_CODE_END - K1_PCREF)
    v_cmp_gt_u32 vcc, s26, v4
    s_nop 3
    s_and_saveexec_b64 s[28:29], vcc
    s_cbranch_execz K1_CPFR
    global_load_dword v255, v4, s[24:25]
K1_CPFR:
    s_mov_b64 exec, s[28:29]
K1_NOCPF:
    v_and_b32 v1, 63, v0
    v_lshrrev_b32 v4, 6, v0
    v_lshrrev_b32 v2, 4, v1
    v_readfirstlane_b32 s44, v4
    s_nop 3
    v_and_b32 v3, 15, v1
    s_and_b32 s63, s2, 7
    s_lshr_b32 s64, s2, 3
    s_lshr_b32 s65, s63, 2
    s_and_b32 s66, s63, 3
    s_lshl_b32 s45, s65, 3
    s_and_b32 s65, s64, 7
    s_add_u32 s45, s45, s65
    s_lshl_b32 s66, s66, 2
    s_lshr_b32 s64, s64, 3
    s_add_u32 s66, s66, s64
    s_and_b32 s47, s66, 1
    s_lshr_b32 s46, s66, 1
    s_mov_b32 s73, 16384
    s_mov_b32 s74, 4294885376
    s_mov_b32 s75, 4294934528
    s_mov_b32 s50, 0
    s_mov_b32 s59, 0
    s_mov_b32 s60, 0
    s_lshr_b32 s48, s44, 1
    s_and_b32 s49, s44, 1
    s_sub_u32 s62, s44, 4
    s_sub_u32 s71, s46, 3
    s_lshl_b32 s71, s71, 4
    s_add_u32 s71, s71, s45
    s_cmp_lt_u32 s46, 3
    s_cselect_b32 s71, 1000, s71
    s_cmp_eq_u32 s47, 0
    s_cselect_b32 s71, 1000, s71
    s_waitcnt lgkmcnt(0)
    s_mov_b32 s24, s8
    s_mov_b32 s25, s9
    s_mov_b32 s26, 2621440
    s_mov_b32 s27, 0x20000
    s_mov_b32 s32, s22
    s_mov_b32 s33, s23
    s_mov_b32 s34, 16312320
    s_mov_b32 s35, 0x20000
    s_mov_b32 s28, s10
    s_mov_b32 s29, s11
    s_mov_b32 s30, 2457600
    s_mov_b32 s31, 0x20000
    s_cmp_lt_u32 s44, 4
    s_cbranch_scc1 K1_COMPUTE
    v_mov_b32 v16, 2147483632
    v_mov_b32 v17, 2147483632
    v_mov_b32 v18, 2147483632
    v_mov_b32 v19, 2147483632
    v_mov_b32 v20, 2147483632
    v_mov_b32 v21, 2147483632
    v_mov_b32 v22, 2147483632
    v_mov_b32 v23, 2147483632
    v_mov_b32 v40, 0
    v_mov_b32 v41, 0
    v_lshrrev_b32 v4, 5, v1
    v_bfe_u32 v5, v1, 2, 3
    v_and_b32 v6, 3, v1
    s_lshl_b32 s63, s45, 7
    s_lshl_b32 s64, s62, 5
    s_add_u32 s63, s63, s64
    v_lshrrev_b32 v7, 2, v5
    v_add_u32 v7, 0, v7
    v_sub_u32 v7, 4, v7
    v_and_b32 v7, 3, v7
    v_xor_b32 v7, v6, v7
    v_lshl_add_u32 v7, v4, 2, v7
    v_add_u32 v8, s63, v5
    v_mul_u32_u24 v8, 1280, v8
    v_lshl_add_u32 v20, v7, 4, v8
    v_lshrrev_b32 v7, 2, v5
    v_add_u32 v7, 2, v7
    v_sub_u32 v7, 4, v7
    v_and_b32 v7, 3, v7
    v_xor_b32 v7, v6, v7
    v_lshl_add_u32 v7, v4, 2, v7
    v_add_u32 v8, s63, v5
    v_add_u32 v8, 8, v8
    v_mul_u32_u24 v8, 1280, v8
    v_lshl_add_u32 v21, v7, 4, v8
    v_subrev_u32 v21, 1024, v21
    v_lshrrev_b32 v7, 2, v5
    v_add_u32 v7, 0, v7
    v_sub_u32 v7, 4, v7
    v_and_b32 v7, 3, v7
    v_xor_b32 v7, v6, v7
    v_lshl_add_u32 v7, v4, 2, v7
    v_add_u32 v8, s63, v5
    v_add_u32 v8, 16, v8
    v_mul_u32_u24 v8, 1280, v8
    v_lshl_add_u32 v22, v7, 4, v8
    v_lshrrev_b32 v7, 2, v5
    v_add_u32 v7, 2, v7
    v_sub_u32 v7, 4, v7
    v_and_b32 v7, 3, v7
    v_xor_b32 v7, v6, v7
    v_lshl_add_u32 v7, v4, 2, v7
    v_add_u32 v8, s63, v5
    v_add_u32 v8, 24, v8
    v_mul_u32_u24 v8, 1280, v8
    v_lshl_add_u32 v23, v7, 4, v8
    v_subrev_u32 v23, 1024, v23
    s_lshl_b32 s56, s62, 12
    s_add_u32 s56, s56, 98304
    s_add_u32 m0, s56, 0
    s_mov_b32 s55, 0
    buffer_load_dwordx4 v20, s[24:27], s55 offen offset:0  lds
    buffer_load_dwordx4 v21, s[24:27], s55 offen offset:1024  lds
    s_add_u32 m0, s56, 2048
    s_mov_b32 s55, 0
    buffer_load_dwordx4 v22, s[24:27], s55 offen offset:0  lds
    buffer_load_dwordx4 v23, s[24:27], s55 offen offset:1024  lds
    s_lshl_b32 s53, s62, 12
    s_add_u32 s53, s53, 0
    s_cmp_eq_u32 s47, 0
    s_cbranch_scc1 K1_LKV
    s_lshl_b32 s63, s46, 2
    s_add_u32 s63, s63, s62
    s_add_u32 s63, s63, 8
    s_branch K1_LPLAIN
K1_LKV:
    s_cmp_lt_u32 s62, 3
    s_cbranch_scc1 K1_LSEG
    s_mov_b32 s63, s46
K1_LPLAIN:
    s_cmp_lt_u32 s63, 10
    s_cselect_b32 s28, s10, s16
    s_cselect_b32 s29, s11, s17
    s_mov_b32 s30, 2457600
    s_cselect_b32 s30, s30, 2211840
    s_mov_b32 s65, 3840
    s_cselect_b32 s65, s65, 3456
    s_cselect_b32 s66, 0, 10
    s_sub_u32 s66, s63, s66
    s_lshl_b32 s66, s66, 7
    s_lshl_b32 s52, s65, 5
    s_cmp_lt_u32 s63, 37
    s_cselect_b32 s66, s66, 2147483632
    v_xor_b32 v7, 0, v6
    v_lshl_add_u32 v7, v4, 2, v7
    v_add_u32 v8, 0, v5
    v_mul_lo_u32 v8, v8, s65
    v_lshl_add_u32 v8, v7, 4, v8
    v_add_u32 v8, s66, v8
    v_mov_b32 v16, v8
    v_xor_b32 v7, 1, v6
    v_lshl_add_u32 v7, v4, 2, v7
    v_add_u32 v8, 8, v5
    v_mul_lo_u32 v8, v8, s65
    v_lshl_add_u32 v8, v7, 4, v8
    v_add_u32 v8, s66, v8
    v_subrev_u32 v17, 1024, v8
    v_xor_b32 v7, 0, v6
    v_lshl_add_u32 v7, v4, 2, v7
    v_add_u32 v8, 16, v5
    v_mul_lo_u32 v8, v8, s65
    v_lshl_add_u32 v8, v7, 4, v8
    v_add_u32 v8, s66, v8
    v_subrev_u32 v18, 2048, v8
    v_xor_b32 v7, 1, v6
    v_lshl_add_u32 v7, v4, 2, v7
    v_add_u32 v8, 24, v5
    v_mul_lo_u32 v8, v8, s65
    v_lshl_add_u32 v8, v7, 4, v8
    v_add_u32 v8, s66, v8
    v_subrev_u32 v19, 3072, v8
    s_branch K1_LWDONE
K1_LSEG:
    s_mov_b32 s52, 122880
    s_mul_i32 s66, s46, 160
    s_lshl_b32 s63, s62, 2
    s_add_u32 s63, s63, 0
    s_cmp_ge_u32 s63, 6
    s_cselect_b32 s64, 6, 0
    s_mov_b32 s65, 2560
    s_cselect_b32 s65, s65, 1280
    s_sub_u32 s63, s63, s64
    s_lshl_b32 s63, s63, 6
    s_add_u32 s65, s65, s66
    v_add_u32 v7, s63, v1
    v_mul_u32_u24 v8, 373, v7
    v_lshrrev_b32 v8, 15, v8
    v_mul_u32_u24 v9, 88, v8
    v_sub_u32 v9, v7, v9
    v_mul_u32_u24 v34, 103, v9
    v_lshrrev_b32 v34, 10, v34
    v_mul_u32_u24 v35, 10, v34
    v_sub_u32 v35, v9, v35
    v_lshl_add_u32 v34, v8, 3, v34
    v_mul_u32_u24 v34, 3840, v34
    v_lshl_add_u32 v34, v35, 4, v34
    v_add_u32 v34, s65, v34
    v_cmp_gt_u32 vcc, 80, v9
    v_mov_b32 v35, 2147483632
    v_cndmask_b32 v34, v35, v34, vcc
    v_cmp_gt_u32 vcc, 352, v7
    s_nop 1
    v_cndmask_b32 v16, v35, v34, vcc
    s_lshl_b32 s63, s62, 2
    s_add_u32 s63, s63, 1
    s_cmp_ge_u32 s63, 6
    s_cselect_b32 s64, 6, 0
    s_mov_b32 s65, 2560
    s_cselect_b32 s65, s65, 1280
    s_sub_u32 s63, s63, s64
    s_lshl_b32 s63, s63, 6
    s_add_u32 s65, s65, s66
    v_add_u32 v7, s63, v1
    v_mul_u32_u24 v8, 373, v7
    v_lshrrev_b32 v8, 15, v8
    v_mul_u32_u24 v9, 88, v8
    v_sub_u32 v9, v7, v9
    v_mul_u32_u24 v34, 103, v9
    v_lshrrev_b32 v34, 10, v34
    v_mul_u32_u24 v35, 10, v34
    v_sub_u32 v35, v9, v35
    v_lshl_add_u32 v34, v8, 3, v34
    v_mul_u32_u24 v34, 3840, v34
    v_lshl_add_u32 v34, v35, 4, v34
    v_add_u32 v34, s65, v34
    v_subrev_u32 v34, 1024, v34
    v_cmp_gt_u32 vcc, 80, v9
    v_mov_b32 v35, 2147483632
    v_cndmask_b32 v34, v35, v34, vcc
    v_cmp_gt_u32 vcc, 352, v7
    s_nop 1
    v_cndmask_b32 v17, v35, v34, vcc
    s_lshl_b32 s63, s62, 2
    s_add_u32 s63, s63, 2
    s_cmp_ge_u32 s63, 6
    s_cselect_b32 s64, 6, 0
    s_mov_b32 s65, 2560
    s_cselect_b32 s65, s65, 1280
    s_sub_u32 s63, s63, s64
    s_lshl_b32 s63, s63, 6
    s_add_u32 s65, s65, s66
    v_add_u32 v7, s63, v1
    v_mul_u32_u24 v8, 373, v7
    v_lshrrev_b32 v8, 15, v8
    v_mul_u32_u24 v9, 88, v8
    v_sub_u32 v9, v7, v9
    v_mul_u32_u24 v34, 103, v9
    v_lshrrev_b32 v34, 10, v34
    v_mul_u32_u24 v35, 10, v34
    v_sub_u32 v35, v9, v35
    v_lshl_add_u32 v34, v8, 3, v34
    v_mul_u32_u24 v34, 3840, v34
    v_lshl_add_u32 v34, v35, 4, v34
    v_add_u32 v34, s65, v34
    v_subrev_u32 v34, 2048, v34
    v_cmp_gt_u32 vcc, 80, v9
    v_mov_b32 v35, 2147483632
    v_cndmask_b32 v34, v35, v34, vcc
    v_cmp_gt_u32 vcc, 352, v7
    s_nop 1
    v_cndmask_b32 v18, v35, v34, vcc
    s_lshl_b32 s63, s62, 2
    s_add_u32 s63, s63, 3
    s_cmp_ge_u32 s63, 6
    s_cselect_b32 s64, 6, 0
    s_mov_b32 s65, 2560
    s_cselect_b32 s65, s65, 1280
    s_sub_u32 s63, s63, s64
    s_lshl_b32 s63, s63, 6
    s_add_u32 s65, s65, s66
    v_add_u32 v7, s63, v1
    v_mul_u32_u24 v8, 373, v7
    v_lshrrev_b32 v8, 15, v8
    v_mul_u32_u24 v9, 88, v8
    v_sub_u32 v9, v7, v9
    v_mul_u32_u24 v34, 103, v9
    v_lshrrev_b32 v34, 10, v34
    v_mul_u32_u24 v35, 10, v34
    v_sub_u32 v35, v9, v35
    v_lshl_add_u32 v34, v8, 3, v34
    v_mul_u32_u24 v34, 3840, v34
    v_lshl_add_u32 v34, v35, 4, v34
    v_add_u32 v34, s65, v34
    v_subrev_u32 v34, 3072, v34
    v_cmp_gt_u32 vcc, 80, v9
    v_mov_b32 v35, 2147483632
    v_cndmask_b32 v34, v35, v34, vcc
    v_cmp_gt_u32 vcc, 352, v7
    s_nop 1
    v_cndmask_b32 v19, v35, v34, vcc
K1_LWDONE:
    s_mov_b32 s31, 0x20000
    s_mov_b32 s51, 0
    s_add_u32 m0, s53, 0
    s_nop 0
    buffer_load_dwordx4 v16, s[28:31], s51 offen offset:0  lds
    buffer_load_dwordx4 v17, s[28:31], s51 offen offset:1024  lds
    buffer_load_dwordx4 v18, s[28:31], s51 offen offset:2048  lds
    buffer_load_dwordx4 v19, s[28:31], s51 offen offset:3072  lds
    s_add_u32 s51, s51, s52
    s_add_u32 m0, s53, 16384
    s_nop 0
    buffer_load_dwordx4 v16, s[28:31], s51 offen offset:0  lds
    buffer_load_dwordx4 v17, s[28:31], s51 offen offset:1024  lds
    buffer_load_dwordx4 v18, s[28:31], s51 offen offset:2048  lds
    buffer_load_dwordx4 v19, s[28:31], s51 offen offset:3072  lds
    s_add_u32 s51, s51, s52
    s_add_u32 m0, s56, 16384
    s_mov_b32 s55, 128
    buffer_load_dwordx4 v20, s[24:27], s55 offen offset:0  lds
    buffer_load_dwordx4 v21, s[24:27], s55 offen offset:1024  lds
    s_add_u32 m0, s56, 18432
    s_mov_b32 s55, 128
    buffer_load_dwordx4 v22, s[24:27], s55 offen offset:0  lds
    buffer_load_dwordx4 v23, s[24:27], s55 offen offset:1024  lds
    v_mov_b32 v4, 0
    v_mov_b32 v5, 0
    v_mov_b32 v6, 0
    v_mov_b32 v7, 0
    v_lshlrev_b32 v8, 4, v1
    v_add_u32 v8, 155136, v8
    ds_write_b128 v8, v[4:7]
    s_waitcnt vmcnt(8) lgkmcnt(0)
    s_barrier
    s_waitcnt vmcnt(4)
    s_barrier
    s_add_u32 m0, s53, 32768
    s_nop 0
    buffer_load_dwordx4 v16, s[28:31], s51 offen offset:0  lds
    buffer_load_dwordx4 v17, s[28:31], s51 offen offset:1024  lds
    buffer_load_dwordx4 v18, s[28:31], s51 offen offset:2048  lds
    buffer_load_dwordx4 v19, s[28:31], s51 offen offset:3072  lds
    s_add_u32 s51, s51, s52
    s_add_u32 m0, s53, 49152
    s_nop 0
    buffer_load_dwordx4 v16, s[28:31], s51 offen offset:0  lds
    buffer_load_dwordx4 v17, s[28:31], s51 offen offset:1024  lds
    buffer_load_dwordx4 v18, s[28:31], s51 offen offset:2048  lds
    buffer_load_dwordx4 v19, s[28:31], s51 offen offset:3072  lds
    s_add_u32 s51, s51, s52
    s_add_u32 m0, s56, 32768
    s_mov_b32 s55, 256
    buffer_load_dwordx4 v20, s[24:27], s55 offen offset:0  lds
    buffer_load_dwordx4 v21, s[24:27], s55 offen offset:1024  lds
    s_waitcnt vmcnt(6)
    s_barrier
    s_add_u32 m0, s56, 34816
    s_mov_b32 s55, 256
    buffer_load_dwordx4 v22, s[24:27], s55 offen offset:0  lds
    buffer_load_dwordx4 v23, s[24:27], s55 offen offset:1024  lds
    s_add_u32 m0, s53, 65536
    s_nop 0
    buffer_load_dwordx4 v16, s[28:31], s51 offen offset:0  lds
    buffer_load_dwordx4 v17, s[28:31], s51 offen offset:1024  lds
    buffer_load_dwordx4 v18, s[28:31], s51 offen offset:2048  lds
    buffer_load_dwordx4 v19, s[28:31], s51 offen offset:3072  lds
    s_add_u32 s51, s51, s52
    s_add_u32 m0, s53, 81920
    s_nop 0
    buffer_load_dwordx4 v16, s[28:31], s51 offen offset:0  lds
    buffer_load_dwordx4 v17, s[28:31], s51 offen offset:1024  lds
    buffer_load_dwordx4 v18, s[28:31], s51 offen offset:2048  lds
    buffer_load_dwordx4 v19, s[28:31], s51 offen offset:3072  lds
    s_add_u32 s51, s51, s52
    s_waitcnt vmcnt(12)
    s_barrier
    s_add_u32 m0, s56, 0
    s_mov_b32 s55, 384
    buffer_load_dwordx4 v20, s[24:27], s55 offen offset:0  lds
    buffer_load_dwordx4 v21, s[24:27], s55 offen offset:1024  lds
    s_add_u32 m0, s56, 2048
    s_mov_b32 s55, 384
    buffer_load_dwordx4 v22, s[24:27], s55 offen offset:0  lds
    buffer_load_dwordx4 v23, s[24:27], s55 offen offset:1024  lds
    s_add_u32 m0, s53, 0
    s_nop 0
    buffer_load_dwordx4 v16, s[28:31], s51 offen offset:0  lds
    buffer_load_dwordx4 v17, s[28:31], s51 offen offset:1024  lds
    buffer_load_dwordx4 v18, s[28:31], s51 offen offset:2048  lds
    buffer_load_dwordx4 v19, s[28:31], s51 offen offset:3072  lds
    s_add_u32 s51, s51, s52
    s_waitcnt vmcnt(12)
    s_barrier
    s_add_u32 m0, s53, 16384
    s_nop 0
    buffer_load_dwordx4 v16, s[28:31], s51 offen offset:0  lds
    buffer_load_dwordx4 v17, s[28:31], s51 offen offset:1024  lds
    buffer_load_dwordx4 v18, s[28:31], s51 offen offset:2048  lds
    buffer_load_dwordx4 v19, s[28:31], s51 offen offset:3072  lds
    s_add_u32 s51, s51, s52
    s_add_u32 m0, s56, 16384
    s_mov_b32 s55, 512
    buffer_load_dwordx4 v20, s[24:27], s55 offen offset:0  lds
    buffer_load_dwordx4 v21, s[24:27], s55 offen offset:1024  lds
    s_add_u32 m0, s56, 18432
    s_mov_b32 s55, 512
    buffer_load_dwordx4 v22, s[24:27], s55 offen offset:0  lds
    buffer_load_dwordx4 v23, s[24:27], s55 offen offset:1024  lds
    s_waitcnt vmcnt(16)
    s_barrier
    s_add_u32 m0, s53, 32768
    s_nop 0
    buffer_load_dwordx4 v16, s[28:31], s51 offen offset:0  lds
    buffer_load_dwordx4 v17, s[28:31], s51 offen offset:1024  lds
    buffer_load_dwordx4 v18, s[28:31], s51 offen offset:2048  lds
    buffer_load_dwordx4 v19, s[28:31], s51 offen offset:3072  lds
    s_add_u32 s51, s51, s52
    s_add_u32 m0, s53, 49152
    s_nop 0
    buffer_load_dwordx4 v16, s[28:31], s51 offen offset:0  lds
    buffer_load_dwordx4 v17, s[28:31], s51 offen offset:1024  lds
    buffer_load_dwordx4 v18, s[28:31], s51 offen offset:2048  lds
    buffer_load_dwordx4 v19, s[28:31], s51 offen offset:3072  lds
    s_add_u32 s51, s51, s52
    s_cmp_eq_u32 s62, 0
    s_cbranch_scc0 K1_NOSIG
    s_lshl_b32 s63, s45, 4
    v_mov_b32 v40, s63
    v_mov_b32 v41, 1
    s_mov_b64 exec, 1
    global_atomic_add v40, v41, s[20:21]
    s_mov_b64 exec, -1
K1_NOSIG:
    s_waitcnt vmcnt(16)
    s_barrier
    s_add_u32 m0, s56, 32768
    s_mov_b32 s55, 640
    buffer_load_dwordx4 v20, s[24:27], s55 offen offset:0  lds
    buffer_load_dwordx4 v21, s[24:27], s55 offen offset:1024  lds
    s_add_u32 m0, s56, 34816
    s_mov_b32 s55, 640
    buffer_load_dwordx4 v22, s[24:27], s55 offen offset:0  lds
    buffer_load_dwordx4 v23, s[24:27], s55 offen offset:1024  lds
    s_add_u32 m0, s53, 65536
    s_nop 0
    buffer_load_dwordx4 v16, s[28:31], s51 offen offset:0  lds
    buffer_load_dwordx4 v17, s[28:31], s51 offen offset:1024  lds
    buffer_load_dwordx4 v18, s[28:31], s51 offen offset:2048  lds
    buffer_load_dwordx4 v19, s[28:31], s51 offen offset:3072  lds
    s_add_u32 s51, s51, s52
    s_waitcnt vmcnt(20)
    s_barrier
    s_add_u32 m0, s53, 81920
    s_nop 0
    buffer_load_dwordx4 v16, s[28:31], s51 offen offset:0  lds
    buffer_load_dwordx4 v17, s[28:31], s51 offen offset:1024  lds
    buffer_load_dwordx4 v18, s[28:31], s51 offen offset:2048  lds
    buffer_load_dwordx4 v19, s[28:31], s51 offen offset:3072  lds
    s_add_u32 s51, s51, s52
    s_waitcnt vmcnt(16)
    s_barrier
    s_add_u32 m0, s56, 0
    s_mov_b32 s55, 768
    buffer_load_dwordx4 v20, s[24:27], s55 offen offset:0  lds
    buffer_load_dwordx4 v21, s[24:27], s55 offen offset:1024  lds
    s_add_u32 m0, s56, 2048
    s_mov_b32 s55, 768
    buffer_load_dwordx4 v22, s[24:27], s55 offen offset:0  lds
    buffer_load_dwordx4 v23, s[24:27], s55 offen offset:1024  lds
    s_add_u32 m0, s53, 0
    s_nop 0
    buffer_load_dwordx4 v16, s[28:31], s51 offen offset:0  lds
    buffer_load_dwordx4 v17, s[28:31], s51 offen offset:1024  lds
    buffer_load_dwordx4 v18, s[28:31], s51 offen offset:2048  lds
    buffer_load_dwordx4 v19, s[28:31], s51 offen offset:3072  lds
    s_add_u32 s51, s51, s52
    s_waitcnt vmcnt(20)
    s_barrier
    s_add_u32 m0, s53, 16384
    s_nop 0
    buffer_load_dwordx4 v16, s[28:31], s51 offen offset:0  lds
    buffer_load_dwordx4 v17, s[28:31], s51 offen offset:1024  lds
    buffer_load_dwordx4 v18, s[28:31], s51 offen offset:2048  lds
    buffer_load_dwordx4 v19, s[28:31], s51 offen offset:3072  lds
    s_add_u32 s51, s51, s52
    s_waitcnt vmcnt(16)
    s_barrier
    s_add_u32 m0, s56, 16384
    s_mov_b32 s55, 896
    buffer_load_dwordx4 v20, s[24:27], s55 offen offset:0  lds
    buffer_load_dwordx4 v21, s[24:27], s55 offen offset:1024  lds
    s_add_u32 m0, s56, 18432
    s_mov_b32 s55, 896
    buffer_load_dwordx4 v22, s[24:27], s55 offen offset:0  lds
    buffer_load_dwordx4 v23, s[24:27], s55 offen offset:1024  lds
    s_add_u32 m0, s53, 32768
    s_nop 0
    buffer_load_dwordx4 v16, s[28:31], s51 offen offset:0  lds
    buffer_load_dwordx4 v17, s[28:31], s51 offen offset:1024  lds
    buffer_load_dwordx4 v18, s[28:31], s51 offen offset:2048  lds
    buffer_load_dwordx4 v19, s[28:31], s51 offen offset:3072  lds
    s_add_u32 s51, s51, s52
    s_waitcnt vmcnt(20)
    s_barrier
    s_add_u32 m0, s53, 49152
    s_nop 0
    buffer_load_dwordx4 v16, s[28:31], s51 offen offset:0  lds
    buffer_load_dwordx4 v17, s[28:31], s51 offen offset:1024  lds
    buffer_load_dwordx4 v18, s[28:31], s51 offen offset:2048  lds
    buffer_load_dwordx4 v19, s[28:31], s51 offen offset:3072  lds
    s_add_u32 s51, s51, s52
    s_cmp_eq_u32 s62, 0
    s_cbranch_scc0 K1_NOPRE
    s_lshl_b32 s63, s45, 4
    v_mov_b32 v40, s63
    global_load_dword v41, v40, s[20:21] sc1
K1_NOPRE:
    s_waitcnt vmcnt(16)
    s_barrier
    s_add_u32 m0, s56, 32768
    s_mov_b32 s55, 1024
    buffer_load_dwordx4 v20, s[24:27], s55 offen offset:0  lds
    buffer_load_dwordx4 v21, s[24:27], s55 offen offset:1024  lds
    s_add_u32 m0, s56, 34816
    s_mov_b32 s55, 1024
    buffer_load_dwordx4 v22, s[24:27], s55 offen offset:0  lds
    buffer_load_dwordx4 v23, s[24:27], s55 offen offset:1024  lds
    s_add_u32 m0, s53, 65536
    s_nop 0
    buffer_load_dwordx4 v16, s[28:31], s51 offen offset:0  lds
    buffer_load_dwordx4 v17, s[28:31], s51 offen offset:1024  lds
    buffer_load_dwordx4 v18, s[28:31], s51 offen offset:2048  lds
    buffer_load_dwordx4 v19, s[28:31], s51 offen offset:3072  lds
    s_add_u32 s51, s51, s52
    s_waitcnt vmcnt(20)
    s_barrier
    s_add_u32 m0, s53, 81920
    s_nop 0
    buffer_load_dwordx4 v16, s[28:31], s51 offen offset:0  lds
    buffer_load_dwordx4 v17, s[28:31], s51 offen offset:1024  lds
    buffer_load_dwordx4 v18, s[28:31], s51 offen offset:2048  lds
    buffer_load_dwordx4 v19, s[28:31], s51 offen offset:3072  lds
    s_add_u32 s51, s51, s52
    s_waitcnt vmcnt(16)
    s_barrier
    s_add_u32 m0, s56, 0
    s_mov_b32 s55, 1152
    buffer_load_dwordx4 v20, s[24:27], s55 offen offset:0  lds
    buffer_load_dwordx4 v21, s[24:27], s55 offen offset:1024  lds
    s_add_u32 m0, s56, 2048
    s_mov_b32 s55, 1152
    buffer_load_dwordx4 v22, s[24:27], s55 offen offset:0  lds
    buffer_load_dwordx4 v23, s[24:27], s55 offen offset:1024  lds
    s_add_u32 m0, s53, 0
    s_nop 0
    buffer_load_dwordx4 v16, s[28:31], s51 offen offset:0  lds
    buffer_load_dwordx4 v17, s[28:31], s51 offen offset:1024  lds
    buffer_load_dwordx4 v18, s[28:31], s51 offen offset:2048  lds
    buffer_load_dwordx4 v19, s[28:31], s51 offen offset:3072  lds
    s_add_u32 s51, s51, s52
    s_waitcnt vmcnt(20)
    s_barrier
    s_add_u32 m0, s53, 16384
    s_nop 0
    buffer_load_dwordx4 v16, s[28:31], s51 offen offset:0  lds
    buffer_load_dwordx4 v17, s[28:31], s51 offen offset:1024  lds
    buffer_load_dwordx4 v18, s[28:31], s51 offen offset:2048  lds
    buffer_load_dwordx4 v19, s[28:31], s51 offen offset:3072  lds
    s_add_u32 s51, s51, s52
    s_waitcnt vmcnt(16)
    s_barrier
    s_mov_b32 s40, s12
    s_mov_b32 s41, s13
    s_mov_b32 s42, 3200
    s_mov_b32 s43, 0x20000
    s_mul_i32 s63, s46, 3200
    s_add_u32 s40, s12, s63
    s_addc_u32 s41, s13, 0
    s_cmp_eq_u32 s62, 0
    s_cbranch_scc0 K1_NOPOLL
    s_lshl_b32 s63, s45, 4
    v_mov_b32 v40, s63
    s_mov_b32 s69, 200000
    v_readfirstlane_b32 s68, v41
    s_nop 3
    s_cmp_ge_u32 s68, 16
    s_cbranch_scc1 K1_SREADY
K1_SPOLL:
    global_load_dword v41, v40, s[20:21] sc1
    s_waitcnt vmcnt(0)
    v_readfirstlane_b32 s68, v41
    s_nop 3
    s_cmp_ge_u32 s68, 16
    s_cbranch_scc1 K1_SREADY
    s_sleep 4
    s_sub_u32 s69, s69, 1
    s_cbranch_scc0 K1_SPOLL
K1_SREADY:
    s_lshl_b32 s63, s45, 10
    s_add_u32 s63, s63, 16270336
    v_lshlrev_b32 v40, 4, v1
    s_mov_b32 m0, 147456
    s_nop 0
    buffer_load_dwordx4 v40, s[32:35], s63 offen sc1 lds
K1_NOPOLL:
    s_waitcnt vmcnt(12)
    s_barrier
    s_cmp_eq_u32 s47, 0
    s_cbranch_scc0 K1_NOPHI
    s_lshl_b32 s63, s62, 10
    v_lshlrev_b32 v7, 4, v1
    v_add_u32 v7, s63, v7
    s_add_u32 m0, s63, 151040
    s_nop 0
    buffer_load_dwordx4 v7, s[40:43], 0 offen lds
K1_NOPHI:
    s_mov_b32 s36, s18
    s_mov_b32 s37, s19
    s_mov_b32 s38, 2211840
    s_mov_b32 s39, 0x20000
    s_cmp_lt_u32 s71, 54
    s_cselect_b32 s36, s18, s14
    s_cselect_b32 s37, s19, s15
    s_cselect_b32 s38, s38, 819200
    s_sub_u32 s64, s71, 54
    s_cmp_lt_u32 s71, 54
    s_cselect_b32 s63, s71, s64
    s_lshl_b32 s63, s63, 5
    s_lshl_b32 s64, s62, 3
    s_add_u32 s63, s63, s64
    s_mul_i32 s70, s63, 1280
    v_lshrrev_b32 v7, 4, v1
    v_and_b32 v8, 15, v1
    v_add_u32 v9, 0, v7
    v_lshlrev_b32 v34, 1, v9
    v_xor_b32 v34, v8, v34
    v_mul_u32_u24 v9, 1280, v9
    v_lshl_add_u32 v24, v34, 4, v9
    v_add_u32 v9, 4, v7
    v_lshlrev_b32 v34, 1, v9
    v_xor_b32 v34, v8, v34
    v_mul_u32_u24 v9, 1280, v9
    v_lshl_add_u32 v25, v34, 4, v9
    s_waitcnt vmcnt(4)
    s_barrier
    s_cmp_lt_u32 s71, 74
    s_cbranch_scc0 K1_NJ_1
    s_lshl_b32 s63, s62, 11
    s_add_u32 s63, s63, 32768
    s_add_u32 m0, s63, 0
    s_add_u32 s64, s70, 0
    buffer_load_dwordx4 v24, s[36:39], s64 offen lds
    s_add_u32 m0, s63, 1024
    s_add_u32 s64, s70, 0
    buffer_load_dwordx4 v25, s[36:39], s64 offen lds
    s_add_u32 m0, s63, 8192
    s_add_u32 s64, s70, 256
    buffer_load_dwordx4 v24, s[36:39], s64 offen lds
    s_add_u32 m0, s63, 9216
    s_add_u32 s64, s70, 256
    buffer_load_dwordx4 v25, s[36:39], s64 offen lds
    s_add_u32 m0, s63, 16384
    s_add_u32 s64, s70, 512
    buffer_load_dwordx4 v24, s[36:39], s64 offen lds
    s_add_u32 m0, s63, 17408
    s_add_u32 s64, s70, 512
    buffer_load_dwordx4 v25, s[36:39], s64 offen lds
    s_add_u32 m0, s63, 24576
    s_add_u32 s64, s70, 768
    buffer_load_dwordx4 v24, s[36:39], s64 offen lds
    s_add_u32 m0, s63, 25600
    s_add_u32 s64, s70, 768
    buffer_load_dwordx4 v25, s[36:39], s64 offen lds
    s_add_u32 m0, s63, 32768
    s_add_u32 s64, s70, 1024
    buffer_load_dwordx4 v24, s[36:39], s64 offen lds
    s_add_u32 m0, s63, 33792
    s_add_u32 s64, s70, 1024
    buffer_load_dwordx4 v25, s[36:39], s64 offen lds
K1_NJ_1:
    s_waitcnt vmcnt(0)
    s_barrier
    s_barrier
    s_waitcnt vmcnt(0) lgkmcnt(0)
    s_barrier
    s_add_u32 s63, s2, s62
    s_cmp_eq_u32 s63, 0
    s_cbranch_scc0 K1_NOFLG
    v_lshlrev_b32 v7, 4, v1
    v_mov_b32 v40, 0
    v_mov_b32 v41, 0
    v_mov_b32 v42, 0
    v_mov_b32 v43, 0
    s_mov_b32 s63, 16269312
    buffer_store_dwordx4 v[40:43], v7, s[32:35], s63 offen
K1_NOFLG:
    s_cmp_eq_u32 s47, 0
    s_cbranch_scc1 K1_KV_E2
    s_cmp_lt_u32 s71, 74
    s_cbranch_scc0 K1_END
    v_bfe_u32 v4, v1, 2, 2
    v_and_b32 v5, 3, v1
    v_and_b32 v6, 1, v2
    s_cmp_lt_u32 s71, 54
    s_cselect_b32 s63, 1, 0
    v_and_b32 v6, s63, v6
    v_xor_b32 v7, 0, v6
    v_lshl_add_u32 v8, v2, 1, v7
    v_lshlrev_b32 v8, 10, v8
    v_lshl_add_u32 v8, v4, 8, v8
    v_lshl_add_u32 v7, v7, 2, v4
    v_lshlrev_b32 v7, 1, v7
    s_mul_i32 s64, s62, 20
    s_add_u32 s64, s64, 0
    v_add_u32 v9, s64, v5
    v_lshrrev_b32 v10, 4, v9
    v_and_b32 v9, 15, v9
    v_xor_b32 v9, v9, v7
    v_lshl_add_u32 v9, v9, 4, v8
    v_lshl_add_u32 v9, v10, 13, v9
    ds_read_b64_tr_b16 v[80:81], v9 offset:32768
    s_mul_i32 s64, s62, 20
    s_add_u32 s64, s64, 0
    v_add_u32 v9, s64, v5
    v_lshrrev_b32 v10, 4, v9
    v_and_b32 v9, 15, v9
    v_xor_b32 v9, v9, v7
    v_lshl_add_u32 v9, v9, 4, v8
    v_lshl_add_u32 v9, v10, 13, v9
    ds_read_b64_tr_b16 v[84:85], v9 offset:32776
    s_mul_i32 s64, s62, 20
    s_add_u32 s64, s64, 4
    v_add_u32 v9, s64, v5
    v_lshrrev_b32 v10, 4, v9
    v_and_b32 v9, 15, v9
    v_xor_b32 v9, v9, v7
    v_lshl_add_u32 v9, v9, 4, v8
    v_lshl_add_u32 v9, v10, 13, v9
    ds_read_b64_tr_b16 v[88:89], v9 offset:32768
    s_mul_i32 s64, s62, 20
    s_add_u32 s64, s64, 4
    v_add_u32 v9, s64, v5
    v_lshrrev_b32 v10, 4, v9
    v_and_b32 v9, 15, v9
    v_xor_b32 v9, v9, v7
    v_lshl_add_u32 v9, v9, 4, v8
    v_lshl_add_u32 v9, v10, 13, v9
    ds_read_b64_tr_b16 v[92:93], v9 offset:32776
    s_mul_i32 s64, s62, 20
    s_add_u32 s64, s64, 8
    v_lshrrev_b32 v9, 1, v5
    v_add_u32 v9, s64, v9
    v_lshrrev_b32 v10, 4, v9
    v_and_b32 v9, 15, v9
    v_xor_b32 v9, v9, v7
    v_lshl_add_u32 v9, v9, 4, v8
    v_lshl_add_u32 v9, v10, 13, v9
    v_and_b32 v10, 1, v5
    v_lshl_add_u32 v9, v10, 3, v9
    ds_read_b64_tr_b16 v[96:97], v9 offset:32768
    s_mul_i32 s64, s62, 20
    s_add_u32 s64, s64, 10
    v_add_u32 v9, s64, v5
    v_lshrrev_b32 v10, 4, v9
    v_and_b32 v9, 15, v9
    v_xor_b32 v9, v9, v7
    v_lshl_add_u32 v9, v9, 4, v8
    v_lshl_add_u32 v9, v10, 13, v9
    ds_read_b64_tr_b16 v[100:101], v9 offset:32768
    s_mul_i32 s64, s62, 20
    s_add_u32 s64, s64, 10
    v_add_u32 v9, s64, v5
    v_lshrrev_b32 v10, 4, v9
    v_and_b32 v9, 15, v9
    v_xor_b32 v9, v9, v7
    v_lshl_add_u32 v9, v9, 4, v8
    v_lshl_add_u32 v9, v10, 13, v9
    ds_read_b64_tr_b16 v[104:105], v9 offset:32776
    s_mul_i32 s64, s62, 20
    s_add_u32 s64, s64, 14
    v_add_u32 v9, s64, v5
    v_lshrrev_b32 v10, 4, v9
    v_and_b32 v9, 15, v9
    v_xor_b32 v9, v9, v7
    v_lshl_add_u32 v9, v9, 4, v8
    v_lshl_add_u32 v9, v10, 13, v9
    ds_read_b64_tr_b16 v[108:109], v9 offset:32768
    s_mul_i32 s64, s62, 20
    s_add_u32 s64, s64, 14
    v_add_u32 v9, s64, v5
    v_lshrrev_b32 v10, 4, v9
    v_and_b32 v9, 15, v9
    v_xor_b32 v9, v9, v7
    v_lshl_add_u32 v9, v9, 4, v8
    v_lshl_add_u32 v9, v10, 13, v9
    ds_read_b64_tr_b16 v[112:113], v9 offset:32776
    s_mul_i32 s64, s62, 20
    s_add_u32 s64, s64, 18
    v_lshrrev_b32 v9, 1, v5
    v_add_u32 v9, s64, v9
    v_lshrrev_b32 v10, 4, v9
    v_and_b32 v9, 15, v9
    v_xor_b32 v9, v9, v7
    v_lshl_add_u32 v9, v9, 4, v8
    v_lshl_add_u32 v9, v10, 13, v9
    v_and_b32 v10, 1, v5
    v_lshl_add_u32 v9, v10, 3, v9
    ds_read_b64_tr_b16 v[116:117], v9 offset:32768
    v_xor_b32 v7, 1, v6
    v_lshl_add_u32 v8, v2, 1, v7
    v_lshlrev_b32 v8, 10, v8
    v_lshl_add_u32 v8, v4, 8, v8
    v_lshl_add_u32 v7, v7, 2, v4
    v_lshlrev_b32 v7, 1, v7
    s_mul_i32 s64, s62, 20
    s_add_u32 s64, s64, 0
    v_add_u32 v9, s64, v5
    v_lshrrev_b32 v10, 4, v9
    v_and_b32 v9, 15, v9
    v_xor_b32 v9, v9, v7
    v_lshl_add_u32 v9, v9, 4, v8
    v_lshl_add_u32 v9, v10, 13, v9
    ds_read_b64_tr_b16 v[82:83], v9 offset:32768
    s_mul_i32 s64, s62, 20
    s_add_u32 s64, s64, 0
    v_add_u32 v9, s64, v5
    v_lshrrev_b32 v10, 4, v9
    v_and_b32 v9, 15, v9
    v_xor_b32 v9, v9, v7
    v_lshl_add_u32 v9, v9, 4, v8
    v_lshl_add_u32 v9, v10, 13, v9
    ds_read_b64_tr_b16 v[86:87], v9 offset:32776
    s_mul_i32 s64, s62, 20
    s_add_u32 s64, s64, 4
    v_add_u32 v9, s64, v5
    v_lshrrev_b32 v10, 4, v9
    v_and_b32 v9, 15, v9
    v_xor_b32 v9, v9, v7
    v_lshl_add_u32 v9, v9, 4, v8
    v_lshl_add_u32 v9, v10, 13, v9
    ds_read_b64_tr_b16 v[90:91], v9 offset:32768
    s_mul_i32 s64, s62, 20
    s_add_u32 s64, s64, 4
    v_add_u32 v9, s64, v5
    v_lshrrev_b32 v10, 4, v9
    v_and_b32 v9, 15, v9
    v_xor_b32 v9, v9, v7
    v_lshl_add_u32 v9, v9, 4, v8
    v_lshl_add_u32 v9, v10, 13, v9
    ds_read_b64_tr_b16 v[94:95], v9 offset:32776
    s_mul_i32 s64, s62, 20
    s_add_u32 s64, s64, 8
    v_lshrrev_b32 v9, 1, v5
    v_add_u32 v9, s64, v9
    v_lshrrev_b32 v10, 4, v9
    v_and_b32 v9, 15, v9
    v_xor_b32 v9, v9, v7
    v_lshl_add_u32 v9, v9, 4, v8
    v_lshl_add_u32 v9, v10, 13, v9
    v_and_b32 v10, 1, v5
    v_lshl_add_u32 v9, v10, 3, v9
    ds_read_b64_tr_b16 v[98:99], v9 offset:32768
    s_mul_i32 s64, s62, 20
    s_add_u32 s64, s64, 10
    v_add_u32 v9, s64, v5
    v_lshrrev_b32 v10, 4, v9
    v_and_b32 v9, 15, v9
    v_xor_b32 v9, v9, v7
    v_lshl_add_u32 v9, v9, 4, v8
    v_lshl_add_u32 v9, v10, 13, v9
    ds_read_b64_tr_b16 v[102:103], v9 offset:32768
    s_mul_i32 s64, s62, 20
    s_add_u32 s64, s64, 10
    v_add_u32 v9, s64, v5
    v_lshrrev_b32 v10, 4, v9
    v_and_b32 v9, 15, v9
    v_xor_b32 v9, v9, v7
    v_lshl_add_u32 v9, v9, 4, v8
    v_lshl_add_u32 v9, v10, 13, v9
    ds_read_b64_tr_b16 v[106:107], v9 offset:32776
    s_mul_i32 s64, s62, 20
    s_add_u32 s64, s64, 14
    v_add_u32 v9, s64, v5
    v_lshrrev_b32 v10, 4, v9
    v_and_b32 v9, 15, v9
    v_xor_b32 v9, v9, v7
    v_lshl_add_u32 v9, v9, 4, v8
    v_lshl_add_u32 v9, v10, 13, v9
    ds_read_b64_tr_b16 v[110:111], v9 offset:32768
    s_mul_i32 s64, s62, 20
    s_add_u32 s64, s64, 14
    v_add_u32 v9, s64, v5
    v_lshrrev_b32 v10, 4, v9
    v_and_b32 v9, 15, v9
    v_xor_b32 v9, v9, v7
    v_lshl_add_u32 v9, v9, 4, v8
    v_lshl_add_u32 v9, v10, 13, v9
    ds_read_b64_tr_b16 v[114:115], v9 offset:32776
    s_mul_i32 s64, s62, 20
    s_add_u32 s64, s64, 18
    v_lshrrev_b32 v9, 1, v5
    v_add_u32 v9, s64, v9
    v_lshrrev_b32 v10, 4, v9
    v_and_b32 v9, 15, v9
    v_xor_b32 v9, v9, v7
    v_lshl_add_u32 v9, v9, 4, v8
    v_lshl_add_u32 v9, v10, 13, v9
    v_and_b32 v10, 1, v5
    v_lshl_add_u32 v9, v10, 3, v9
    ds_read_b64_tr_b16 v[118:119], v9 offset:32768
    v_lshlrev_b32 v4, 4, v1
    s_waitcnt lgkmcnt(0)
    s_lshl_b32 s63, s62, 1
    s_add_u32 s63, s63, 0
    s_mul_i32 s63, s63, 74
    s_add_u32 s63, s63, s71
    s_mul_i32 s63, s63, 5120
    s_add_u32 s63, s63, 10616832
    s_add_u32 s64, s63, 4096
    buffer_store_dwordx4 v[80:83], v4, s[32:35], s63 offen offset:0 sc1
    buffer_store_dwordx4 v[84:87], v4, s[32:35], s63 offen offset:1024 sc1
    buffer_store_dwordx4 v[88:91], v4, s[32:35], s63 offen offset:2048 sc1
    buffer_store_dwordx4 v[92:95], v4, s[32:35], s63 offen offset:3072 sc1
    buffer_store_dwordx4 v[96:99], v4, s[32:35], s64 offen offset:0 sc1
    s_lshl_b32 s63, s62, 1
    s_add_u32 s63, s63, 1
    s_mul_i32 s63, s63, 74
    s_add_u32 s63, s63, s71
    s_mul_i32 s63, s63, 5120
    s_add_u32 s63, s63, 10616832
    s_add_u32 s64, s63, 4096
    buffer_store_dwordx4 v[100:103], v4, s[32:35], s63 offen offset:0 sc1
    buffer_store_dwordx4 v[104:107], v4, s[32:35], s63 offen offset:1024 sc1
    buffer_store_dwordx4 v[108:111], v4, s[32:35], s63 offen offset:2048 sc1
    buffer_store_dwordx4 v[112:115], v4, s[32:35], s63 offen offset:3072 sc1
    buffer_store_dwordx4 v[116:119], v4, s[32:35], s64 offen offset:0 sc1
    s_branch K1_END
K1_COMPUTE:
    s_lshl_b32 s63, s46, 1
    s_add_u32 s63, s63, s47
    s_lshl_b32 s63, s63, 3
    s_lshl_b32 s64, s45, 7
    s_add_u32 s63, s63, s64
    s_lshl_b32 s64, s44, 1
    s_add_u32 s63, s63, s64
    v_lshrrev_b32 v4, 5, v1
    v_add_u32 v4, s63, v4
    v_and_b32 v5, 31, v1
    v_mul_u32_u24 v6, 1280, v4
    v_lshl_add_u32 v6, v5, 4, v6
    v_mov_b32 v7, 2147483632
    v_cmp_gt_u32 vcc, 16, v5
    s_nop 1
    v_cndmask_b32 v7, v7, v6, vcc
    buffer_load_dwordx4 v[16:19], v6, s[24:27], 0 offen
    buffer_load_dwordx4 v[20:23], v6, s[24:27], 0 offen offset:512
    buffer_load_dwordx4 v[24:27], v7, s[24:27], 0 offen offset:1024
    v_lshlrev_b32 v9, 3, v4
    s_setprio 2
    v_lshrrev_b32 v4, 2, v3
    v_sub_u32 v4, 4, v4
    v_and_b32 v4, 3, v4
    v_xor_b32 v4, v2, v4
    v_lshlrev_b32 v4, 4, v4
    v_lshrrev_b32 v5, 3, v3
    v_lshl_add_u32 v4, v5, 10, v4
    v_and_b32 v5, 7, v3
    v_lshl_add_u32 v4, v5, 6, v4
    s_lshl_b32 s63, s48, 13
    s_add_u32 s63, s63, 98304
    v_add_u32 v10, s63, v4
    v_bfe_u32 v4, v1, 2, 2
    v_and_b32 v5, 3, v1
    v_mul_u32_u24 v6, 1408, v2
    v_mul_u32_u24 v7, 160, v4
    v_add_u32 v6, v6, v7
    v_mul_u32_u24 v7, 40, v5
    v_add_u32 v6, v6, v7
    s_mul_i32 s63, s49, 6144
    v_add_u32 v13, s63, v6
    s_lshl_b32 s63, s49, 13
    s_lshl_b32 s64, s49, 9
    s_add_u32 s64, s64, 12288
    s_cmp_eq_u32 s47, 1
    s_cselect_b32 s63, s63, s64
    v_and_b32 v6, 1, v2
    v_xor_b32 v6, v5, v6
    v_lshlrev_b32 v6, 4, v6
    v_lshl_add_u32 v6, v2, 10, v6
    v_lshl_add_u32 v6, v4, 6, v6
    v_add_u32 v6, s63, v6
    v_and_b32 v7, 1, v5
    v_lshl_add_u32 v11, v7, 3, v6
    v_xor_b32 v12, 8, v11
    v_mov_b32 v4, 0x3f803f80
    v_cmp_eq_u32 vcc, 0, v3
    s_nop 1
    v_cndmask_b32 v80, 0, v4, vcc
    v_cndmask_b32 v81, 0, v4, vcc
    v_cndmask_b32 v82, 0, v4, vcc
    v_cndmask_b32 v83, 0, v4, vcc
    v_mov_b32 v84, 0
    v_mov_b32 v85, 0
    v_mov_b32 v86, 0
    v_mov_b32 v87, 0
    v_mov_b32 v88, 0
    v_mov_b32 v89, 0
    v_mov_b32 v90, 0
    v_mov_b32 v91, 0
    v_mov_b32 v92, 0
    v_mov_b32 v93, 0
    v_mov_b32 v94, 0
    v_mov_b32 v95, 0
    v_mov_b32 v96, 0
    v_mov_b32 v97, 0
    v_mov_b32 v98, 0
    v_mov_b32 v99, 0
    v_mov_b32 v100, 0
    v_mov_b32 v101, 0
    v_mov_b32 v102, 0
    v_mov_b32 v103, 0
    v_mov_b32 v104, 0
    v_mov_b32 v105, 0
    v_mov_b32 v106, 0
    v_mov_b32 v107, 0
    v_mov_b32 v108, 0
    v_mov_b32 v109, 0
    v_mov_b32 v110, 0
    v_mov_b32 v111, 0
    v_mov_b32 v112, 0
    v_mov_b32 v113, 0
    v_mov_b32 v114, 0
    v_mov_b32 v115, 0
    v_mov_b32 v116, 0
    v_mov_b32 v117, 0
    v_mov_b32 v118, 0
    v_mov_b32 v119, 0
    v_mov_b32 v120, 0
    v_mov_b32 v121, 0
    v_mov_b32 v122, 0
    v_mov_b32 v123, 0
    v_mov_b32 v124, 0
    v_mov_b32 v125, 0
    v_mov_b32 v126, 0
    v_mov_b32 v127, 0
    v_mov_b32 v128, 0
    v_mov_b32 v129, 0
    v_mov_b32 v130, 0
    v_mov_b32 v131, 0
    v_mov_b32 v132, 0
    v_mov_b32 v133, 0
    v_mov_b32 v134, 0
    v_mov_b32 v135, 0
    v_mov_b32 v136, 0
    v_mov_b32 v137, 0
    v_mov_b32 v138, 0
    v_mov_b32 v139, 0
    v_mov_b32 v140, 0
    v_mov_b32 v141, 0
    v_mov_b32 v142, 0
    v_mov_b32 v143, 0
    v_mov_b32 v144, 0
    v_mov_b32 v145, 0
    v_mov_b32 v146, 0
    v_mov_b32 v147, 0
    v_mov_b32 v148, 0
    v_mov_b32 v149, 0
    v_mov_b32 v150, 0
    v_mov_b32 v151, 0
    v_mov_b32 v152, 0
    v_mov_b32 v153, 0
    v_mov_b32 v154, 0
    v_mov_b32 v155, 0
    v_mov_b32 v156, 0
    v_mov_b32 v157, 0
    v_mov_b32 v158, 0
    v_mov_b32 v159, 0
    v_mov_b32 v160, 0
    v_mov_b32 v161, 0
    v_mov_b32 v162, 0
    v_mov_b32 v163, 0
    v_mov_b32 v164, 0
    v_mov_b32 v165, 0
    v_mov_b32 v166, 0
    v_mov_b32 v167, 0
    v_mov_b32 v168, 0
    v_mov_b32 v169, 0
    v_mov_b32 v170, 0
    v_mov_b32 v171, 0
    v_mov_b32 v172, 0
    v_mov_b32 v173, 0
    v_mov_b32 v174, 0
    v_mov_b32 v175, 0
    v_mov_b32 v176, 0
    v_mov_b32 v177, 0
    v_mov_b32 v178, 0
    v_mov_b32 v179, 0
    v_mov_b32 v180, 0
    v_mov_b32 v181, 0
    v_mov_b32 v182, 0
    v_mov_b32 v183, 0
    v_mov_b32 v184, 0
    v_mov_b32 v185, 0
    v_mov_b32 v186, 0
    v_mov_b32 v187, 0
    v_mov_b32 v188, 0
    v_mov_b32 v189, 0
    v_mov_b32 v190, 0
    v_mov_b32 v191, 0
    v_mov_b32 v192, 0
    v_mov_b32 v193, 0
    v_mov_b32 v194, 0
    v_mov_b32 v195, 0
    v_mov_b32 v196, 0
    v_mov_b32 v197, 0
    v_mov_b32 v198, 0
    v_mov_b32 v199, 0
    v_mov_b32 v200, 0
    v_mov_b32 v201, 0
    v_mov_b32 v202, 0
    v_mov_b32 v203, 0
    v_mov_b32 v204, 0
    v_mov_b32 v205, 0
    v_mov_b32 v206, 0
    v_mov_b32 v207, 0
    v_mov_b32 v208, 0
    v_mov_b32 v209, 0
    v_mov_b32 v210, 0
    v_mov_b32 v211, 0
    v_mov_b32 v212, 0
    v_mov_b32 v213, 0
    v_mov_b32 v214, 0
    v_mov_b32 v215, 0
    v_mov_b32 v216, 0
    v_mov_b32 v217, 0
    v_mov_b32 v218, 0
    v_mov_b32 v219, 0
    v_mov_b32 v220, 0
    v_mov_b32 v221, 0
    v_mov_b32 v222, 0
    v_mov_b32 v223, 0
    v_mov_b32 v224, 0
    v_mov_b32 v225, 0
    v_mov_b32 v226, 0
    v_mov_b32 v227, 0
    v_mov_b32 v28, 0
    v_mov_b32 v29, 0
    v_mov_b32 v30, 0
    v_mov_b32 v31, 0
    s_waitcnt vmcnt(0)
    v_lshlrev_b32 v4, 16, v16
    v_and_b32 v5, 0xffff0000, v16
    v_pk_add_f32 v[28:29], v[28:29], v[4:5]
    v_pk_fma_f32 v[30:31], v[4:5], v[4:5], v[30:31]
    v_lshlrev_b32 v4, 16, v17
    v_and_b32 v5, 0xffff0000, v17
    v_pk_add_f32 v[28:29], v[28:29], v[4:5]
    v_pk_fma_f32 v[30:31], v[4:5], v[4:5], v[30:31]
    v_lshlrev_b32 v4, 16, v18
    v_and_b32 v5, 0xffff0000, v18
    v_pk_add_f32 v[28:29], v[28:29], v[4:5]
    v_pk_fma_f32 v[30:31], v[4:5], v[4:5], v[30:31]
    v_lshlrev_b32 v4, 16, v19
    v_and_b32 v5, 0xffff0000, v19
    v_pk_add_f32 v[28:29], v[28:29], v[4:5]
    v_pk_fma_f32 v[30:31], v[4:5], v[4:5], v[30:31]
    v_lshlrev_b32 v4, 16, v20
    v_and_b32 v5, 0xffff0000, v20
    v_pk_add_f32 v[28:29], v[28:29], v[4:5]
    v_pk_fma_f32 v[30:31], v[4:5], v[4:5], v[30:31]
    v_lshlrev_b32 v4, 16, v21
    v_and_b32 v5, 0xffff0000, v21
    v_pk_add_f32 v[28:29], v[28:29], v[4:5]
    v_pk_fma_f32 v[30:31], v[4:5], v[4:5], v[30:31]
    v_lshlrev_b32 v4, 16, v22
    v_and_b32 v5, 0xffff0000, v22
    v_pk_add_f32 v[28:29], v[28:29], v[4:5]
    v_pk_fma_f32 v[30:31], v[4:5], v[4:5], v[30:31]
    v_lshlrev_b32 v4, 16, v23
    v_and_b32 v5, 0xffff0000, v23
    v_pk_add_f32 v[28:29], v[28:29], v[4:5]
    v_pk_fma_f32 v[30:31], v[4:5], v[4:5], v[30:31]
    v_lshlrev_b32 v4, 16, v24
    v_and_b32 v5, 0xffff0000, v24
    v_pk_add_f32 v[28:29], v[28:29], v[4:5]
    v_pk_fma_f32 v[30:31], v[4:5], v[4:5], v[30:31]
    v_lshlrev_b32 v4, 16, v25
    v_and_b32 v5, 0xffff0000, v25
    v_pk_add_f32 v[28:29], v[28:29], v[4:5]
    v_pk_fma_f32 v[30:31], v[4:5], v[4:5], v[30:31]
    v_lshlrev_b32 v4, 16, v26
    v_and_b32 v5, 0xffff0000, v26
    v_pk_add_f32 v[28:29], v[28:29], v[4:5]
    v_pk_fma_f32 v[30:31], v[4:5], v[4:5], v[30:31]
    v_lshlrev_b32 v4, 16, v27
    v_and_b32 v5, 0xffff0000, v27
    v_pk_add_f32 v[28:29], v[28:29], v[4:5]
    v_pk_fma_f32 v[30:31], v[4:5], v[4:5], v[30:31]
    v_add_f32 v28, v28, v29
    v_add_f32 v30, v30, v31
    s_nop 1
    v_add_f32_dpp v28, v28, v28 quad_perm:[1,0,3,2] row_mask:0xf bank_mask:0xf
    v_add_f32_dpp v30, v30, v30 quad_perm:[1,0,3,2] row_mask:0xf bank_mask:0xf
    s_nop 1
    v_add_f32_dpp v28, v28, v28 quad_perm:[2,3,0,1] row_mask:0xf bank_mask:0xf
    v_add_f32_dpp v30, v30, v30 quad_perm:[2,3,0,1] row_mask:0xf bank_mask:0xf
    s_nop 1
    v_add_f32_dpp v28, v28, v28 row_half_mirror row_mask:0xf bank_mask:0xf
    v_add_f32_dpp v30, v30, v30 row_half_mirror row_mask:0xf bank_mask:0xf
    s_nop 1
    v_add_f32_dpp v28, v28, v28 row_mirror row_mask:0xf bank_mask:0xf
    v_add_f32_dpp v30, v30, v30 row_mirror row_mask:0xf bank_mask:0xf
    v_mov_b32 v4, v28
    s_nop 1
    v_permlane16_swap_b32 v4, v28
    s_nop 1
    v_add_f32 v28, v28, v4
    v_mov_b32 v4, v30
    s_nop 1
    v_permlane16_swap_b32 v4, v30
    s_nop 1
    v_add_f32 v30, v30, v4
    s_mov_b32 s67, 0x3acccccd
    v_mul_f32 v28, s67, v28
    v_mul_f32 v30, s67, v30
    v_fma_f32 v30, -v28, v28, v30
    v_max_f32 v30, 0, v30
    v_cvt_pk_bf16_f32 v32, v28, v28
    v_lshlrev_b32 v28, 16, v32
    v_cvt_pk_bf16_f32 v32, v30, v30
    v_lshlrev_b32 v30, 16, v32
    v_add_f32 v30, 0x3727c5ac, v30
    v_cvt_pk_bf16_f32 v32, v30, v30
    v_lshlrev_b32 v30, 16, v32
    v_sqrt_f32 v30, v30
    s_nop 0
    v_cvt_pk_bf16_f32 v32, v30, v30
    v_lshlrev_b32 v30, 16, v32
    v_rcp_f32 v32, v30
    s_nop 0
    v_mul_f32 v33, v28, v32
    v_sub_f32 v33, 0, v33
    s_mov_b32 s63, 16270336
    v_and_b32 v4, 31, v1
    v_mov_b32 v5, 2147483632
    v_cmp_eq_u32 vcc, 0, v4
    s_nop 1
    v_cndmask_b32 v9, v5, v9, vcc
    buffer_store_dwordx2 v[32:33], v9, s[32:35], s63 offen sc1
    s_barrier
    s_cmp_eq_u32 s47, 1
    s_cbranch_scc1 K1_P8
    ds_read_b128 v[16:19], v10 offset:0
    ds_read_b128 v[20:23], v10 offset:2048
    ds_read_b128 v[24:27], v10 offset:4096
    ds_read_b128 v[28:31], v10 offset:6144
    ds_read_b64_tr_b16 v[48:49], v13 offset:0
    ds_read_b64_tr_b16 v[50:51], v13 offset:640
    ds_read_b64_tr_b16 v[52:53], v13 offset:8
    ds_read_b64_tr_b16 v[54:55], v13 offset:648
    ds_read_b64_tr_b16 v[56:57], v13 offset:16
    ds_read_b64_tr_b16 v[58:59], v13 offset:656
    ds_read_b64_tr_b16 v[60:61], v13 offset:24
    ds_read_b64_tr_b16 v[62:63], v13 offset:664
    ds_read_b64_tr_b16 v[64:65], v13 offset:32
    ds_read_b64_tr_b16 v[66:67], v13 offset:672
    ds_read_b64_tr_b16 v[68:69], v11 offset:0
    ds_read_b64_tr_b16 v[70:71], v11 offset:256
    ds_read_b64_tr_b16 v[72:73], v12 offset:0
    ds_read_b64_tr_b16 v[74:75], v12 offset:256
    s_cmp_eq_u32 s48, 0
    s_cbranch_scc0 K1_KV7_B
K1_KV7_LA:
    s_waitcnt lgkmcnt(12)
    s_add_u32 s59, s59, 1
    s_cmp_eq_u32 s59, 6
    s_cselect_b32 s58, s74, s73
    s_cselect_b32 s59, 0, s59
    v_mfma_f32_16x16x32_bf16 v[100:103], v[48:51], v[16:19], v[100:103]
    v_add_u32 v11, s58, v11
    v_add_u32 v12, s58, v12
    v_mfma_f32_16x16x32_bf16 v[104:107], v[48:51], v[20:23], v[104:107]
    v_add_u32 v13, s58, v13
    v_mfma_f32_16x16x32_bf16 v[108:111], v[48:51], v[24:27], v[108:111]
    v_mfma_f32_16x16x32_bf16 v[112:115], v[48:51], v[28:31], v[112:115]
    s_barrier
    v_mfma_f32_16x16x32_bf16 v[84:87], v[48:51], v[80:83], v[84:87]
    s_waitcnt lgkmcnt(10)
    v_mfma_f32_16x16x32_bf16 v[116:119], v[52:55], v[16:19], v[116:119]
    ds_read_b128 v[32:35], v10 offset:512
    ds_read_b128 v[36:39], v10 offset:2560
    ds_read_b128 v[40:43], v10 offset:4608
    ds_read_b128 v[44:47], v10 offset:6656
    v_mfma_f32_16x16x32_bf16 v[120:123], v[52:55], v[20:23], v[120:123]
    ds_read_b64_tr_b16 v[48:49], v13 offset:0
    ds_read_b64_tr_b16 v[50:51], v13 offset:640
    v_mfma_f32_16x16x32_bf16 v[124:127], v[52:55], v[24:27], v[124:127]
    v_mfma_f32_16x16x32_bf16 v[128:131], v[52:55], v[28:31], v[128:131]
    v_mfma_f32_16x16x32_bf16 v[88:91], v[52:55], v[80:83], v[88:91]
    s_waitcnt lgkmcnt(14)
    v_mfma_f32_16x16x32_bf16 v[132:135], v[56:59], v[16:19], v[132:135]
    v_mfma_f32_16x16x32_bf16 v[136:139], v[56:59], v[20:23], v[136:139]
    ds_read_b64_tr_b16 v[52:53], v13 offset:8
    ds_read_b64_tr_b16 v[54:55], v13 offset:648
    v_mfma_f32_16x16x32_bf16 v[140:143], v[56:59], v[24:27], v[140:143]
    v_mfma_f32_16x16x32_bf16 v[144:147], v[56:59], v[28:31], v[144:147]
    v_mfma_f32_16x16x32_bf16 v[92:95], v[56:59], v[80:83], v[92:95]
    s_waitcnt lgkmcnt(14)
    v_mfma_f32_16x16x32_bf16 v[148:151], v[60:63], v[16:19], v[148:151]
    v_mfma_f32_16x16x32_bf16 v[152:155], v[60:63], v[20:23], v[152:155]
    ds_read_b64_tr_b16 v[56:57], v13 offset:16
    ds_read_b64_tr_b16 v[58:59], v13 offset:656
    v_mfma_f32_16x16x32_bf16 v[156:159], v[60:63], v[24:27], v[156:159]
    v_mfma_f32_16x16x32_bf16 v[160:163], v[60:63], v[28:31], v[160:163]
    v_mfma_f32_16x16x32_bf16 v[96:99], v[60:63], v[80:83], v[96:99]
    s_waitcnt lgkmcnt(14)
    v_mfma_f32_16x16x32_bf16 v[164:167], v[64:67], v[16:19], v[164:167]
    v_mfma_f32_16x16x32_bf16 v[168:171], v[64:67], v[20:23], v[168:171]
    ds_read_b64_tr_b16 v[60:61], v13 offset:24
    ds_read_b64_tr_b16 v[62:63], v13 offset:664
    v_mfma_f32_16x16x32_bf16 v[172:175], v[64:67], v[24:27], v[172:175]
    v_mfma_f32_16x16x32_bf16 v[176:179], v[64:67], v[28:31], v[176:179]
    s_waitcnt lgkmcnt(14)
    v_mfma_f32_16x16x32_bf16 v[180:183], v[68:71], v[16:19], v[180:183]
    v_mfma_f32_16x16x32_bf16 v[184:187], v[68:71], v[20:23], v[184:187]
    ds_read_b64_tr_b16 v[64:65], v13 offset:32
    ds_read_b64_tr_b16 v[66:67], v13 offset:672
    v_mfma_f32_16x16x32_bf16 v[188:191], v[68:71], v[24:27], v[188:191]
    v_mfma_f32_16x16x32_bf16 v[192:195], v[68:71], v[28:31], v[192:195]
    s_waitcnt lgkmcnt(14)
    v_mfma_f32_16x16x32_bf16 v[196:199], v[72:75], v[16:19], v[196:199]
    v_mfma_f32_16x16x32_bf16 v[200:203], v[72:75], v[20:23], v[200:203]
    ds_read_b64_tr_b16 v[68:69], v11 offset:0
    ds_read_b64_tr_b16 v[70:71], v11 offset:256
    v_mfma_f32_16x16x32_bf16 v[204:207], v[72:75], v[24:27], v[204:207]
    v_mfma_f32_16x16x32_bf16 v[208:211], v[72:75], v[28:31], v[208:211]
    ds_read_b64_tr_b16 v[72:73], v12 offset:0
    ds_read_b64_tr_b16 v[74:75], v12 offset:256
    s_cmp_eq_u32 s50, 2
    s_cbranch_scc0 Lst_2
    s_waitcnt vmcnt(0)
Lst_2:
    s_waitcnt lgkmcnt(12)
    s_add_u32 s59, s59, 1
    s_cmp_eq_u32 s59, 6
    s_cselect_b32 s58, s74, s73
    s_cselect_b32 s59, 0, s59
    s_add_u32 s60, s60, 1
    s_cmp_eq_u32 s60, 3
    s_cselect_b32 s61, s75, s73
    s_cselect_b32 s60, 0, s60
    v_mfma_f32_16x16x32_bf16 v[100:103], v[48:51], v[32:35], v[100:103]
    v_add_u32 v11, s58, v11
    v_add_u32 v12, s58, v12
    v_mfma_f32_16x16x32_bf16 v[104:107], v[48:51], v[36:39], v[104:107]
    v_add_u32 v13, s58, v13
    v_add_u32 v10, s61, v10
    v_mfma_f32_16x16x32_bf16 v[108:111], v[48:51], v[40:43], v[108:111]
    v_mfma_f32_16x16x32_bf16 v[112:115], v[48:51], v[44:47], v[112:115]
    s_barrier
    v_mfma_f32_16x16x32_bf16 v[84:87], v[48:51], v[80:83], v[84:87]
    s_waitcnt lgkmcnt(10)
    v_mfma_f32_16x16x32_bf16 v[116:119], v[52:55], v[32:35], v[116:119]
    ds_read_b128 v[16:19], v10 offset:0
    ds_read_b128 v[20:23], v10 offset:2048
    ds_read_b128 v[24:27], v10 offset:4096
    ds_read_b128 v[28:31], v10 offset:6144
    v_mfma_f32_16x16x32_bf16 v[120:123], v[52:55], v[36:39], v[120:123]
    ds_read_b64_tr_b16 v[48:49], v13 offset:0
    ds_read_b64_tr_b16 v[50:51], v13 offset:640
    v_mfma_f32_16x16x32_bf16 v[124:127], v[52:55], v[40:43], v[124:127]
    v_mfma_f32_16x16x32_bf16 v[128:131], v[52:55], v[44:47], v[128:131]
    v_mfma_f32_16x16x32_bf16 v[88:91], v[52:55], v[80:83], v[88:91]
    s_waitcnt lgkmcnt(14)
    v_mfma_f32_16x16x32_bf16 v[132:135], v[56:59], v[32:35], v[132:135]
    v_mfma_f32_16x16x32_bf16 v[136:139], v[56:59], v[36:39], v[136:139]
    ds_read_b64_tr_b16 v[52:53], v13 offset:8
    ds_read_b64_tr_b16 v[54:55], v13 offset:648
    v_mfma_f32_16x16x32_bf16 v[140:143], v[56:59], v[40:43], v[140:143]
    v_mfma_f32_16x16x32_bf16 v[144:147], v[56:59], v[44:47], v[144:147]
    v_mfma_f32_16x16x32_bf16 v[92:95], v[56:59], v[80:83], v[92:95]
    s_waitcnt lgkmcnt(14)
    v_mfma_f32_16x16x32_bf16 v[148:151], v[60:63], v[32:35], v[148:151]
    v_mfma_f32_16x16x32_bf16 v[152:155], v[60:63], v[36:39], v[152:155]
    ds_read_b64_tr_b16 v[56:57], v13 offset:16
    ds_read_b64_tr_b16 v[58:59], v13 offset:656
    v_mfma_f32_16x16x32_bf16 v[156:159], v[60:63], v[40:43], v[156:159]
    v_mfma_f32_16x16x32_bf16 v[160:163], v[60:63], v[44:47], v[160:163]
    v_mfma_f32_16x16x32_bf16 v[96:99], v[60:63], v[80:83], v[96:99]
    s_waitcnt lgkmcnt(14)
    v_mfma_f32_16x16x32_bf16 v[164:167], v[64:67], v[32:35], v[164:167]
    v_mfma_f32_16x16x32_bf16 v[168:171], v[64:67], v[36:39], v[168:171]
    ds_read_b64_tr_b16 v[60:61], v13 offset:24
    ds_read_b64_tr_b16 v[62:63], v13 offset:664
    v_mfma_f32_16x16x32_bf16 v[172:175], v[64:67], v[40:43], v[172:175]
    v_mfma_f32_16x16x32_bf16 v[176:179], v[64:67], v[44:47], v[176:179]
    s_waitcnt lgkmcnt(14)
    v_mfma_f32_16x16x32_bf16 v[180:183], v[68:71], v[32:35], v[180:183]
    v_mfma_f32_16x16x32_bf16 v[184:187], v[68:71], v[36:39], v[184:187]
    ds_read_b64_tr_b16 v[64:65], v13 offset:32
    ds_read_b64_tr_b16 v[66:67], v13 offset:672
    v_mfma_f32_16x16x32_bf16 v[188:191], v[68:71], v[40:43], v[188:191]
    v_mfma_f32_16x16x32_bf16 v[192:195], v[68:71], v[44:47], v[192:195]
    s_waitcnt lgkmcnt(14)
    v_mfma_f32_16x16x32_bf16 v[196:199], v[72:75], v[32:35], v[196:199]
    v_mfma_f32_16x16x32_bf16 v[200:203], v[72:75], v[36:39], v[200:203]
    ds_read_b64_tr_b16 v[68:69], v11 offset:0
    ds_read_b64_tr_b16 v[70:71], v11 offset:256
    v_mfma_f32_16x16x32_bf16 v[204:207], v[72:75], v[40:43], v[204:207]
    v_mfma_f32_16x16x32_bf16 v[208:211], v[72:75], v[44:47], v[208:211]
    ds_read_b64_tr_b16 v[72:73], v12 offset:0
    ds_read_b64_tr_b16 v[74:75], v12 offset:256
    s_add_u32 s50, s50, 2
    s_cmp_lt_u32 s50, 20
    s_cbranch_scc1 K1_KV7_LA
    s_waitcnt lgkmcnt(0)
    s_nop 7
    s_lshl_b32 s63, s49, 9
    s_add_u32 s63, s63, 148480
    v_lshl_add_u32 v4, v2, 4, s63
    v_mov_b32 v5, 149504
    v_cmp_eq_u32 vcc, 0, v3
    s_nop 1
    v_cndmask_b32 v5, v5, v4, vcc
    ds_write_b128 v5, v[84:87] offset:0
    ds_write_b128 v5, v[88:91] offset:64
    ds_write_b128 v5, v[92:95] offset:128
    ds_write_b128 v5, v[96:99] offset:192
    s_waitcnt lgkmcnt(0)
    s_barrier
    s_lshl_b32 s63, s48, 9
    s_add_u32 s63, s63, 147456
    v_lshl_add_u32 v5, v3, 3, s63
    ds_read_b64 v[16:17], v5 offset:0
    ds_read_b64 v[18:19], v5 offset:128
    ds_read_b64 v[20:21], v5 offset:256
    ds_read_b64 v[22:23], v5 offset:384
    ds_read_b128 v[24:27], v4 offset:0
    ds_read_b128 v[28:31], v4 offset:64
    ds_read_b128 v[32:35], v4 offset:128
    ds_read_b128 v[36:39], v4 offset:192
    ds_read_b128 v[40:43], v4 offset:256
    ds_read_b128 v[44:47], v4 offset:320
    ds_read_b128 v[48:51], v4 offset:384
    s_waitcnt lgkmcnt(0)
    s_branch K1_KV7_EPI
K1_KV7_B:
K1_KV7_LB:
    s_waitcnt lgkmcnt(12)
    s_add_u32 s59, s59, 1
    s_cmp_eq_u32 s59, 6
    s_cselect_b32 s58, s74, s73
    s_cselect_b32 s59, 0, s59
    v_mfma_f32_16x16x32_bf16 v[100:103], v[48:51], v[16:19], v[100:103]
    v_add_u32 v11, s58, v11
    v_add_u32 v12, s58, v12
    v_mfma_f32_16x16x32_bf16 v[104:107], v[48:51], v[20:23], v[104:107]
    v_add_u32 v13, s58, v13
    v_mfma_f32_16x16x32_bf16 v[108:111], v[48:51], v[24:27], v[108:111]
    v_mfma_f32_16x16x32_bf16 v[112:115], v[48:51], v[28:31], v[112:115]
    s_barrier
    s_waitcnt lgkmcnt(10)
    v_mfma_f32_16x16x32_bf16 v[116:119], v[52:55], v[16:19], v[116:119]
    ds_read_b128 v[32:35], v10 offset:512
    ds_read_b128 v[36:39], v10 offset:2560
    ds_read_b128 v[40:43], v10 offset:4608
    ds_read_b128 v[44:47], v10 offset:6656
    v_mfma_f32_16x16x32_bf16 v[120:123], v[52:55], v[20:23], v[120:123]
    ds_read_b64_tr_b16 v[48:49], v13 offset:0
    ds_read_b64_tr_b16 v[50:51], v13 offset:640
    v_mfma_f32_16x16x32_bf16 v[124:127], v[52:55], v[24:27], v[124:127]
    v_mfma_f32_16x16x32_bf16 v[128:131], v[52:55], v[28:31], v[128:131]
    s_waitcnt lgkmcnt(14)
    v_mfma_f32_16x16x32_bf16 v[132:135], v[56:59], v[16:19], v[132:135]
    v_mfma_f32_16x16x32_bf16 v[136:139], v[56:59], v[20:23], v[136:139]
    ds_read_b64_tr_b16 v[52:53], v13 offset:8
    ds_read_b64_tr_b16 v[54:55], v13 offset:648
    v_mfma_f32_16x16x32_bf16 v[140:143], v[56:59], v[24:27], v[140:143]
    v_mfma_f32_16x16x32_bf16 v[144:147], v[56:59], v[28:31], v[144:147]
    s_waitcnt lgkmcnt(14)
    v_mfma_f32_16x16x32_bf16 v[148:151], v[60:63], v[16:19], v[148:151]
    v_mfma_f32_16x16x32_bf16 v[152:155], v[60:63], v[20:23], v[152:155]
    ds_read_b64_tr_b16 v[56:57], v13 offset:16
    ds_read_b64_tr_b16 v[58:59], v13 offset:656
    v_mfma_f32_16x16x32_bf16 v[156:159], v[60:63], v[24:27], v[156:159]
    v_mfma_f32_16x16x32_bf16 v[160:163], v[60:63], v[28:31], v[160:163]
    s_waitcnt lgkmcnt(14)
    v_mfma_f32_16x16x32_bf16 v[164:167], v[64:67], v[16:19], v[164:167]
    v_mfma_f32_16x16x32_bf16 v[168:171], v[64:67], v[20:23], v[168:171]
    ds_read_b64_tr_b16 v[60:61], v13 offset:24
    ds_read_b64_tr_b16 v[62:63], v13 offset:664
    v_mfma_f32_16x16x32_bf16 v[172:175], v[64:67], v[24:27], v[172:175]
    v_mfma_f32_16x16x32_bf16 v[176:179], v[64:67], v[28:31], v[176:179]
    v_mfma_f32_16x16x32_bf16 v[84:87], v[64:67], v[80:83], v[84:87]
    s_waitcnt lgkmcnt(14)
    v_mfma_f32_16x16x32_bf16 v[180:183], v[68:71], v[16:19], v[180:183]
    v_mfma_f32_16x16x32_bf16 v[184:187], v[68:71], v[20:23], v[184:187]
    ds_read_b64_tr_b16 v[64:65], v13 offset:32
    ds_read_b64_tr_b16 v[66:67], v13 offset:672
    v_mfma_f32_16x16x32_bf16 v[188:191], v[68:71], v[24:27], v[188:191]
    v_mfma_f32_16x16x32_bf16 v[192:195], v[68:71], v[28:31], v[192:195]
    v_mfma_f32_16x16x32_bf16 v[88:91], v[68:71], v[80:83], v[88:91]
    s_waitcnt lgkmcnt(14)
    v_mfma_f32_16x16x32_bf16 v[196:199], v[72:75], v[16:19], v[196:199]
    v_mfma_f32_16x16x32_bf16 v[200:203], v[72:75], v[20:23], v[200:203]
    ds_read_b64_tr_b16 v[68:69], v11 offset:0
    ds_read_b64_tr_b16 v[70:71], v11 offset:256
    v_mfma_f32_16x16x32_bf16 v[204:207], v[72:75], v[24:27], v[204:207]
    v_mfma_f32_16x16x32_bf16 v[208:211], v[72:75], v[28:31], v[208:211]
    v_mfma_f32_16x16x32_bf16 v[92:95], v[72:75], v[80:83], v[92:95]
    ds_read_b64_tr_b16 v[72:73], v12 offset:0
    ds_read_b64_tr_b16 v[74:75], v12 offset:256
    s_cmp_eq_u32 s50, 2
    s_cbranch_scc0 Lst_3
    s_waitcnt vmcnt(0)
Lst_3:
    s_waitcnt lgkmcnt(12)
    s_add_u32 s59, s59, 1
    s_cmp_eq_u32 s59, 6
    s_cselect_b32 s58, s74, s73
    s_cselect_b32 s59, 0, s59
    s_add_u32 s60, s60, 1
    s_cmp_eq_u32 s60, 3
    s_cselect_b32 s61, s75, s73
    s_cselect_b32 s60, 0, s60
    v_mfma_f32_16x16x32_bf16 v[100:103], v[48:51], v[32:35], v[100:103]
    v_add_u32 v11, s58, v11
    v_add_u32 v12, s58, v12
    v_mfma_f32_16x16x32_bf16 v[104:107], v[48:51], v[36:39], v[104:107]
    v_add_u32 v13, s58, v13
    v_add_u32 v10, s61, v10
    v_mfma_f32_16x16x32_bf16 v[108:111], v[48:51], v[40:43], v[108:111]
    v_mfma_f32_16x16x32_bf16 v[112:115], v[48:51], v[44:47], v[112:115]
    s_barrier
    s_waitcnt lgkmcnt(10)
    v_mfma_f32_16x16x32_bf16 v[116:119], v[52:55], v[32:35], v[116:119]
    ds_read_b128 v[16:19], v10 offset:0
    ds_read_b128 v[20:23], v10 offset:2048
    ds_read_b128 v[24:27], v10 offset:4096
    ds_read_b128 v[28:31], v10 offset:6144
    v_mfma_f32_16x16x32_bf16 v[120:123], v[52:55], v[36:39], v[120:123]
    ds_read_b64_tr_b16 v[48:49], v13 offset:0
    ds_read_b64_tr_b16 v[50:51], v13 offset:640
    v_mfma_f32_16x16x32_bf16 v[124:127], v[52:55], v[40:43], v[124:127]
    v_mfma_f32_16x16x32_bf16 v[128:131], v[52:55], v[44:47], v[128:131]
    s_waitcnt lgkmcnt(14)
    v_mfma_f32_16x16x32_bf16 v[132:135], v[56:59], v[32:35], v[132:135]
    v_mfma_f32_16x16x32_bf16 v[136:139], v[56:59], v[36:39], v[136:139]
    ds_read_b64_tr_b16 v[52:53], v13 offset:8
    ds_read_b64_tr_b16 v[54:55], v13 offset:648
    v_mfma_f32_16x16x32_bf16 v[140:143], v[56:59], v[40:43], v[140:143]
    v_mfma_f32_16x16x32_bf16 v[144:147], v[56:59], v[44:47], v[144:147]
    s_waitcnt lgkmcnt(14)
    v_mfma_f32_16x16x32_bf16 v[148:151], v[60:63], v[32:35], v[148:151]
    v_mfma_f32_16x16x32_bf16 v[152:155], v[60:63], v[36:39], v[152:155]
    ds_read_b64_tr_b16 v[56:57], v13 offset:16
    ds_read_b64_tr_b16 v[58:59], v13 offset:656
    v_mfma_f32_16x16x32_bf16 v[156:159], v[60:63], v[40:43], v[156:159]
    v_mfma_f32_16x16x32_bf16 v[160:163], v[60:63], v[44:47], v[160:163]
    s_waitcnt lgkmcnt(14)
    v_mfma_f32_16x16x32_bf16 v[164:167], v[64:67], v[32:35], v[164:167]
    v_mfma_f32_16x16x32_bf16 v[168:171], v[64:67], v[36:39], v[168:171]
    ds_read_b64_tr_b16 v[60:61], v13 offset:24
    ds_read_b64_tr_b16 v[62:63], v13 offset:664
    v_mfma_f32_16x16x32_bf16 v[172:175], v[64:67], v[40:43], v[172:175]
    v_mfma_f32_16x16x32_bf16 v[176:179], v[64:67], v[44:47], v[176:179]
    v_mfma_f32_16x16x32_bf16 v[84:87], v[64:67], v[80:83], v[84:87]
    s_waitcnt lgkmcnt(14)
    v_mfma_f32_16x16x32_bf16 v[180:183], v[68:71], v[32:35], v[180:183]
    v_mfma_f32_16x16x32_bf16 v[184:187], v[68:71], v[36:39], v[184:187]
    ds_read_b64_tr_b16 v[64:65], v13 offset:32
    ds_read_b64_tr_b16 v[66:67], v13 offset:672
    v_mfma_f32_16x16x32_bf16 v[188:191], v[68:71], v[40:43], v[188:191]
    v_mfma_f32_16x16x32_bf16 v[192:195], v[68:71], v[44:47], v[192:195]
    v_mfma_f32_16x16x32_bf16 v[88:91], v[68:71], v[80:83], v[88:91]
    s_waitcnt lgkmcnt(14)
    v_mfma_f32_16x16x32_bf16 v[196:199], v[72:75], v[32:35], v[196:199]
    v_mfma_f32_16x16x32_bf16 v[200:203], v[72:75], v[36:39], v[200:203]
    ds_read_b64_tr_b16 v[68:69], v11 offset:0
    ds_read_b64_tr_b16 v[70:71], v11 offset:256
    v_mfma_f32_16x16x32_bf16 v[204:207], v[72:75], v[40:43], v[204:207]
    v_mfma_f32_16x16x32_bf16 v[208:211], v[72:75], v[44:47], v[208:211]
    v_mfma_f32_16x16x32_bf16 v[92:95], v[72:75], v[80:83], v[92:95]
    ds_read_b64_tr_b16 v[72:73], v12 offset:0
    ds_read_b64_tr_b16 v[74:75], v12 offset:256
    s_add_u32 s50, s50, 2
    s_cmp_lt_u32 s50, 20
    s_cbranch_scc1 K1_KV7_LB
    s_waitcnt lgkmcnt(0)
    s_nop 7
    s_lshl_b32 s63, s49, 9
    s_add_u32 s63, s63, 148480
    v_lshl_add_u32 v4, v2, 4, s63
    v_mov_b32 v5, 149504
    v_cmp_eq_u32 vcc, 0, v3
    s_nop 1
    v_cndmask_b32 v5, v5, v4, vcc
    ds_write_b128 v5, v[84:87] offset:256
    ds_write_b128 v5, v[88:91] offset:320
    ds_write_b128 v5, v[92:95] offset:384
    s_waitcnt lgkmcnt(0)
    s_barrier
    s_lshl_b32 s63, s48, 9
    s_add_u32 s63, s63, 147456
    v_lshl_add_u32 v5, v3, 3, s63
    ds_read_b64 v[16:17], v5 offset:0
    ds_read_b64 v[18:19], v5 offset:128
    ds_read_b64 v[20:21], v5 offset:256
    ds_read_b64 v[22:23], v5 offset:384
    ds_read_b128 v[24:27], v4 offset:0
    ds_read_b128 v[28:31], v4 offset:64
    ds_read_b128 v[32:35], v4 offset:128
    ds_read_b128 v[36:39], v4 offset:192
    ds_read_b128 v[40:43], v4 offset:256
    ds_read_b128 v[44:47], v4 offset:320
    ds_read_b128 v[48:51], v4 offset:384
    s_waitcnt lgkmcnt(0)
K1_KV7_EPI:
    s_mul_i32 s63, s49, 26624
    s_mul_i32 s64, s48, 13312
    s_add_u32 s63, s63, s64
    v_mul_u32_u24 v4, 208, v3
    v_mul_u32_u24 v5, 48, v2
    v_add_u32 v4, v4, v5
    v_add_u32 v4, s63, v4
    s_mul_i32 s65, s49, 0x3f80
    v_pk_mul_f32 v[228:229], v[24:25], v[16:17] op_sel:[0,1] op_sel_hi:[1,1]
    v_pk_fma_f32 v[100:101], v[100:101], v[16:17], v[228:229] op_sel:[0,0,0] op_sel_hi:[1,0,1]
    v_pk_mul_f32 v[228:229], v[26:27], v[16:17] op_sel:[0,1] op_sel_hi:[1,1]
    v_pk_fma_f32 v[102:103], v[102:103], v[16:17], v[228:229] op_sel:[0,0,0] op_sel_hi:[1,0,1]
    v_cvt_pk_bf16_f32 v232, v100, v101
    v_cvt_pk_bf16_f32 v233, v102, v103
    v_pk_mul_f32 v[228:229], v[28:29], v[16:17] op_sel:[0,1] op_sel_hi:[1,1]
    v_pk_fma_f32 v[116:117], v[116:117], v[16:17], v[228:229] op_sel:[0,0,0] op_sel_hi:[1,0,1]
    v_pk_mul_f32 v[228:229], v[30:31], v[16:17] op_sel:[0,1] op_sel_hi:[1,1]
    v_pk_fma_f32 v[118:119], v[118:119], v[16:17], v[228:229] op_sel:[0,0,0] op_sel_hi:[1,0,1]
    v_cvt_pk_bf16_f32 v234, v116, v117
    v_cvt_pk_bf16_f32 v235, v118, v119
    v_pk_mul_f32 v[228:229], v[32:33], v[16:17] op_sel:[0,1] op_sel_hi:[1,1]
    v_pk_fma_f32 v[132:133], v[132:133], v[16:17], v[228:229] op_sel:[0,0,0] op_sel_hi:[1,0,1]
    v_pk_mul_f32 v[228:229], v[34:35], v[16:17] op_sel:[0,1] op_sel_hi:[1,1]
    v_pk_fma_f32 v[134:135], v[134:135], v[16:17], v[228:229] op_sel:[0,0,0] op_sel_hi:[1,0,1]
    v_cvt_pk_bf16_f32 v236, v132, v133
    v_cvt_pk_bf16_f32 v237, v134, v135
    v_pk_mul_f32 v[228:229], v[36:37], v[16:17] op_sel:[0,1] op_sel_hi:[1,1]
    v_pk_fma_f32 v[148:149], v[148:149], v[16:17], v[228:229] op_sel:[0,0,0] op_sel_hi:[1,0,1]
    v_pk_mul_f32 v[228:229], v[38:39], v[16:17] op_sel:[0,1] op_sel_hi:[1,1]
    v_pk_fma_f32 v[150:151], v[150:151], v[16:17], v[228:229] op_sel:[0,0,0] op_sel_hi:[1,0,1]
    v_cvt_pk_bf16_f32 v238, v148, v149
    v_cvt_pk_bf16_f32 v239, v150, v151
    v_pk_mul_f32 v[228:229], v[40:41], v[16:17] op_sel:[0,1] op_sel_hi:[1,1]
    v_pk_fma_f32 v[164:165], v[164:165], v[16:17], v[228:229] op_sel:[0,0,0] op_sel_hi:[1,0,1]
    v_pk_mul_f32 v[228:229], v[42:43], v[16:17] op_sel:[0,1] op_sel_hi:[1,1]
    v_pk_fma_f32 v[166:167], v[166:167], v[16:17], v[228:229] op_sel:[0,0,0] op_sel_hi:[1,0,1]
    v_cvt_pk_bf16_f32 v240, v164, v165
    v_cvt_pk_bf16_f32 v241, v166, v167
    v_mov_b32 v242, s65
    v_mov_b32 v243, 0
    ds_write_b128 v4, v[232:235] offset:0
    ds_write_b128 v4, v[236:239] offset:16
    ds_write_b128 v4, v[240:243] offset:32
    v_pk_mul_f32 v[228:229], v[24:25], v[18:19] op_sel:[0,1] op_sel_hi:[1,1]
    v_pk_fma_f32 v[104:105], v[104:105], v[18:19], v[228:229] op_sel:[0,0,0] op_sel_hi:[1,0,1]
    v_pk_mul_f32 v[228:229], v[26:27], v[18:19] op_sel:[0,1] op_sel_hi:[1,1]
    v_pk_fma_f32 v[106:107], v[106:107], v[18:19], v[228:229] op_sel:[0,0,0] op_sel_hi:[1,0,1]
    v_cvt_pk_bf16_f32 v244, v104, v105
    v_cvt_pk_bf16_f32 v245, v106, v107
    v_pk_mul_f32 v[228:229], v[28:29], v[18:19] op_sel:[0,1] op_sel_hi:[1,1]
    v_pk_fma_f32 v[120:121], v[120:121], v[18:19], v[228:229] op_sel:[0,0,0] op_sel_hi:[1,0,1]
    v_pk_mul_f32 v[228:229], v[30:31], v[18:19] op_sel:[0,1] op_sel_hi:[1,1]
    v_pk_fma_f32 v[122:123], v[122:123], v[18:19], v[228:229] op_sel:[0,0,0] op_sel_hi:[1,0,1]
    v_cvt_pk_bf16_f32 v246, v120, v121
    v_cvt_pk_bf16_f32 v247, v122, v123
    v_pk_mul_f32 v[228:229], v[32:33], v[18:19] op_sel:[0,1] op_sel_hi:[1,1]
    v_pk_fma_f32 v[136:137], v[136:137], v[18:19], v[228:229] op_sel:[0,0,0] op_sel_hi:[1,0,1]
    v_pk_mul_f32 v[228:229], v[34:35], v[18:19] op_sel:[0,1] op_sel_hi:[1,1]
    v_pk_fma_f32 v[138:139], v[138:139], v[18:19], v[228:229] op_sel:[0,0,0] op_sel_hi:[1,0,1]
    v_cvt_pk_bf16_f32 v248, v136, v137
    v_cvt_pk_bf16_f32 v249, v138, v139
    v_pk_mul_f32 v[228:229], v[36:37], v[18:19] op_sel:[0,1] op_sel_hi:[1,1]
    v_pk_fma_f32 v[152:153], v[152:153], v[18:19], v[228:229] op_sel:[0,0,0] op_sel_hi:[1,0,1]
    v_pk_mul_f32 v[228:229], v[38:39], v[18:19] op_sel:[0,1] op_sel_hi:[1,1]
    v_pk_fma_f32 v[154:155], v[154:155], v[18:19], v[228:229] op_sel:[0,0,0] op_sel_hi:[1,0,1]
    v_cvt_pk_bf16_f32 v250, v152, v153
    v_cvt_pk_bf16_f32 v251, v154, v155
    v_pk_mul_f32 v[228:229], v[40:41], v[18:19] op_sel:[0,1] op_sel_hi:[1,1]
    v_pk_fma_f32 v[168:169], v[168:169], v[18:19], v[228:229] op_sel:[0,0,0] op_sel_hi:[1,0,1]
    v_pk_mul_f32 v[228:229], v[42:43], v[18:19] op_sel:[0,1] op_sel_hi:[1,1]
    v_pk_fma_f32 v[170:171], v[170:171], v[18:19], v[228:229] op_sel:[0,0,0] op_sel_hi:[1,0,1]
    v_cvt_pk_bf16_f32 v252, v168, v169
    v_cvt_pk_bf16_f32 v253, v170, v171
    v_mov_b32 v254, s65
    v_mov_b32 v255, 0
    ds_write_b128 v4, v[244:247] offset:3328
    ds_write_b128 v4, v[248:251] offset:3344
    ds_write_b128 v4, v[252:255] offset:3360
    v_pk_mul_f32 v[228:229], v[24:25], v[20:21] op_sel:[0,1] op_sel_hi:[1,1]
    v_pk_fma_f32 v[108:109], v[108:109], v[20:21], v[228:229] op_sel:[0,0,0] op_sel_hi:[1,0,1]
    v_pk_mul_f32 v[228:229], v[26:27], v[20:21] op_sel:[0,1] op_sel_hi:[1,1]
    v_pk_fma_f32 v[110:111], v[110:111], v[20:21], v[228:229] op_sel:[0,0,0] op_sel_hi:[1,0,1]
    v_cvt_pk_bf16_f32 v232, v108, v109
    v_cvt_pk_bf16_f32 v233, v110, v111
    v_pk_mul_f32 v[228:229], v[28:29], v[20:21] op_sel:[0,1] op_sel_hi:[1,1]
    v_pk_fma_f32 v[124:125], v[124:125], v[20:21], v[228:229] op_sel:[0,0,0] op_sel_hi:[1,0,1]
    v_pk_mul_f32 v[228:229], v[30:31], v[20:21] op_sel:[0,1] op_sel_hi:[1,1]
    v_pk_fma_f32 v[126:127], v[126:127], v[20:21], v[228:229] op_sel:[0,0,0] op_sel_hi:[1,0,1]
    v_cvt_pk_bf16_f32 v234, v124, v125
    v_cvt_pk_bf16_f32 v235, v126, v127
    v_pk_mul_f32 v[228:229], v[32:33], v[20:21] op_sel:[0,1] op_sel_hi:[1,1]
    v_pk_fma_f32 v[140:141], v[140:141], v[20:21], v[228:229] op_sel:[0,0,0] op_sel_hi:[1,0,1]
    v_pk_mul_f32 v[228:229], v[34:35], v[20:21] op_sel:[0,1] op_sel_hi:[1,1]
    v_pk_fma_f32 v[142:143], v[142:143], v[20:21], v[228:229] op_sel:[0,0,0] op_sel_hi:[1,0,1]
    v_cvt_pk_bf16_f32 v236, v140, v141
    v_cvt_pk_bf16_f32 v237, v142, v143
    v_pk_mul_f32 v[228:229], v[36:37], v[20:21] op_sel:[0,1] op_sel_hi:[1,1]
    v_pk_fma_f32 v[156:157], v[156:157], v[20:21], v[228:229] op_sel:[0,0,0] op_sel_hi:[1,0,1]
    v_pk_mul_f32 v[228:229], v[38:39], v[20:21] op_sel:[0,1] op_sel_hi:[1,1]
    v_pk_fma_f32 v[158:159], v[158:159], v[20:21], v[228:229] op_sel:[0,0,0] op_sel_hi:[1,0,1]
    v_cvt_pk_bf16_f32 v238, v156, v157
    v_cvt_pk_bf16_f32 v239, v158, v159
    v_pk_mul_f32 v[228:229], v[40:41], v[20:21] op_sel:[0,1] op_sel_hi:[1,1]
    v_pk_fma_f32 v[172:173], v[172:173], v[20:21], v[228:229] op_sel:[0,0,0] op_sel_hi:[1,0,1]
    v_pk_mul_f32 v[228:229], v[42:43], v[20:21] op_sel:[0,1] op_sel_hi:[1,1]
    v_pk_fma_f32 v[174:175], v[174:175], v[20:21], v[228:229] op_sel:[0,0,0] op_sel_hi:[1,0,1]
    v_cvt_pk_bf16_f32 v240, v172, v173
    v_cvt_pk_bf16_f32 v241, v174, v175
    v_mov_b32 v242, s65
    v_mov_b32 v243, 0
    ds_write_b128 v4, v[232:235] offset:6656
    ds_write_b128 v4, v[236:239] offset:6672
    ds_write_b128 v4, v[240:243] offset:6688
    v_pk_mul_f32 v[228:229], v[24:25], v[22:23] op_sel:[0,1] op_sel_hi:[1,1]
    v_pk_fma_f32 v[112:113], v[112:113], v[22:23], v[228:229] op_sel:[0,0,0] op_sel_hi:[1,0,1]
    v_pk_mul_f32 v[228:229], v[26:27], v[22:23] op_sel:[0,1] op_sel_hi:[1,1]
    v_pk_fma_f32 v[114:115], v[114:115], v[22:23], v[228:229] op_sel:[0,0,0] op_sel_hi:[1,0,1]
    v_cvt_pk_bf16_f32 v244, v112, v113
    v_cvt_pk_bf16_f32 v245, v114, v115
    v_pk_mul_f32 v[228:229], v[28:29], v[22:23] op_sel:[0,1] op_sel_hi:[1,1]
    v_pk_fma_f32 v[128:129], v[128:129], v[22:23], v[228:229] op_sel:[0,0,0] op_sel_hi:[1,0,1]
    v_pk_mul_f32 v[228:229], v[30:31], v[22:23] op_sel:[0,1] op_sel_hi:[1,1]
    v_pk_fma_f32 v[130:131], v[130:131], v[22:23], v[228:229] op_sel:[0,0,0] op_sel_hi:[1,0,1]
    v_cvt_pk_bf16_f32 v246, v128, v129
    v_cvt_pk_bf16_f32 v247, v130, v131
    v_pk_mul_f32 v[228:229], v[32:33], v[22:23] op_sel:[0,1] op_sel_hi:[1,1]
    v_pk_fma_f32 v[144:145], v[144:145], v[22:23], v[228:229] op_sel:[0,0,0] op_sel_hi:[1,0,1]
    v_pk_mul_f32 v[228:229], v[34:35], v[22:23] op_sel:[0,1] op_sel_hi:[1,1]
    v_pk_fma_f32 v[146:147], v[146:147], v[22:23], v[228:229] op_sel:[0,0,0] op_sel_hi:[1,0,1]
    v_cvt_pk_bf16_f32 v248, v144, v145
    v_cvt_pk_bf16_f32 v249, v146, v147
    v_pk_mul_f32 v[228:229], v[36:37], v[22:23] op_sel:[0,1] op_sel_hi:[1,1]
    v_pk_fma_f32 v[160:161], v[160:161], v[22:23], v[228:229] op_sel:[0,0,0] op_sel_hi:[1,0,1]
    v_pk_mul_f32 v[228:229], v[38:39], v[22:23] op_sel:[0,1] op_sel_hi:[1,1]
    v_pk_fma_f32 v[162:163], v[162:163], v[22:23], v[228:229] op_sel:[0,0,0] op_sel_hi:[1,0,1]
    v_cvt_pk_bf16_f32 v250, v160, v161
    v_cvt_pk_bf16_f32 v251, v162, v163
    v_pk_mul_f32 v[228:229], v[40:41], v[22:23] op_sel:[0,1] op_sel_hi:[1,1]
    v_pk_fma_f32 v[176:177], v[176:177], v[22:23], v[228:229] op_sel:[0,0,0] op_sel_hi:[1,0,1]
    v_pk_mul_f32 v[228:229], v[42:43], v[22:23] op_sel:[0,1] op_sel_hi:[1,1]
    v_pk_fma_f32 v[178:179], v[178:179], v[22:23], v[228:229] op_sel:[0,0,0] op_sel_hi:[1,0,1]
    v_cvt_pk_bf16_f32 v252, v176, v177
    v_cvt_pk_bf16_f32 v253, v178, v179
    v_mov_b32 v254, s65
    v_mov_b32 v255, 0
    ds_write_b128 v4, v[244:247] offset:9984
    ds_write_b128 v4, v[248:251] offset:10000
    ds_write_b128 v4, v[252:255] offset:10016
    v_lshlrev_b32 v240, 4, v1
    s_lshl_b32 s63, s46, 1
    s_add_u32 s63, s63, s49
    s_lshl_b32 s64, s45, 1
    s_add_u32 s64, s64, s48
    s_mul_i32 s64, s64, 20
    s_add_u32 s63, s63, s64
    s_lshl_b32 s63, s63, 12
    s_add_u32 s63, s63, 7077888
    s_add_u32 s64, s63, 4096
    v_pk_mul_f32 v[228:229], v[44:45], v[16:17] op_sel:[0,1] op_sel_hi:[1,1]
    v_pk_fma_f32 v[180:181], v[180:181], v[16:17], v[228:229] op_sel:[0,0,0] op_sel_hi:[1,0,1]
    v_pk_mul_f32 v[228:229], v[46:47], v[16:17] op_sel:[0,1] op_sel_hi:[1,1]
    v_pk_fma_f32 v[182:183], v[182:183], v[16:17], v[228:229] op_sel:[0,0,0] op_sel_hi:[1,0,1]
    v_cvt_pk_bf16_f32 v232, v180, v181
    v_cvt_pk_bf16_f32 v233, v182, v183
    v_pk_mul_f32 v[228:229], v[48:49], v[16:17] op_sel:[0,1] op_sel_hi:[1,1]
    v_pk_fma_f32 v[196:197], v[196:197], v[16:17], v[228:229] op_sel:[0,0,0] op_sel_hi:[1,0,1]
    v_pk_mul_f32 v[228:229], v[50:51], v[16:17] op_sel:[0,1] op_sel_hi:[1,1]
    v_pk_fma_f32 v[198:199], v[198:199], v[16:17], v[228:229] op_sel:[0,0,0] op_sel_hi:[1,0,1]
    v_cvt_pk_bf16_f32 v234, v196, v197
    v_cvt_pk_bf16_f32 v235, v198, v199
    buffer_store_dwordx4 v[232:235], v240, s[32:35], s63 offen offset:0 sc1
    v_pk_mul_f32 v[228:229], v[44:45], v[18:19] op_sel:[0,1] op_sel_hi:[1,1]
    v_pk_fma_f32 v[184:185], v[184:185], v[18:19], v[228:229] op_sel:[0,0,0] op_sel_hi:[1,0,1]
    v_pk_mul_f32 v[228:229], v[46:47], v[18:19] op_sel:[0,1] op_sel_hi:[1,1]
    v_pk_fma_f32 v[186:187], v[186:187], v[18:19], v[228:229] op_sel:[0,0,0] op_sel_hi:[1,0,1]
    v_cvt_pk_bf16_f32 v236, v184, v185
    v_cvt_pk_bf16_f32 v237, v186, v187
    v_pk_mul_f32 v[228:229], v[48:49], v[18:19] op_sel:[0,1] op_sel_hi:[1,1]
    v_pk_fma_f32 v[200:201], v[200:201], v[18:19], v[228:229] op_sel:[0,0,0] op_sel_hi:[1,0,1]
    v_pk_mul_f32 v[228:229], v[50:51], v[18:19] op_sel:[0,1] op_sel_hi:[1,1]
    v_pk_fma_f32 v[202:203], v[202:203], v[18:19], v[228:229] op_sel:[0,0,0] op_sel_hi:[1,0,1]
    v_cvt_pk_bf16_f32 v238, v200, v201
    v_cvt_pk_bf16_f32 v239, v202, v203
    buffer_store_dwordx4 v[236:239], v240, s[32:35], s63 offen offset:1024 sc1
    v_pk_mul_f32 v[228:229], v[44:45], v[20:21] op_sel:[0,1] op_sel_hi:[1,1]
    v_pk_fma_f32 v[188:189], v[188:189], v[20:21], v[228:229] op_sel:[0,0,0] op_sel_hi:[1,0,1]
    v_pk_mul_f32 v[228:229], v[46:47], v[20:21] op_sel:[0,1] op_sel_hi:[1,1]
    v_pk_fma_f32 v[190:191], v[190:191], v[20:21], v[228:229] op_sel:[0,0,0] op_sel_hi:[1,0,1]
    v_cvt_pk_bf16_f32 v232, v188, v189
    v_cvt_pk_bf16_f32 v233, v190, v191
    v_pk_mul_f32 v[228:229], v[48:49], v[20:21] op_sel:[0,1] op_sel_hi:[1,1]
    v_pk_fma_f32 v[204:205], v[204:205], v[20:21], v[228:229] op_sel:[0,0,0] op_sel_hi:[1,0,1]
    v_pk_mul_f32 v[228:229], v[50:51], v[20:21] op_sel:[0,1] op_sel_hi:[1,1]
    v_pk_fma_f32 v[206:207], v[206:207], v[20:21], v[228:229] op_sel:[0,0,0] op_sel_hi:[1,0,1]
    v_cvt_pk_bf16_f32 v234, v204, v205
    v_cvt_pk_bf16_f32 v235, v206, v207
    buffer_store_dwordx4 v[232:235], v240, s[32:35], s63 offen offset:2048 sc1
    v_pk_mul_f32 v[228:229], v[44:45], v[22:23] op_sel:[0,1] op_sel_hi:[1,1]
    v_pk_fma_f32 v[192:193], v[192:193], v[22:23], v[228:229] op_sel:[0,0,0] op_sel_hi:[1,0,1]
    v_pk_mul_f32 v[228:229], v[46:47], v[22:23] op_sel:[0,1] op_sel_hi:[1,1]
    v_pk_fma_f32 v[194:195], v[194:195], v[22:23], v[228:229] op_sel:[0,0,0] op_sel_hi:[1,0,1]
    v_cvt_pk_bf16_f32 v236, v192, v193
    v_cvt_pk_bf16_f32 v237, v194, v195
    v_pk_mul_f32 v[228:229], v[48:49], v[22:23] op_sel:[0,1] op_sel_hi:[1,1]
    v_pk_fma_f32 v[208:209], v[208:209], v[22:23], v[228:229] op_sel:[0,0,0] op_sel_hi:[1,0,1]
    v_pk_mul_f32 v[228:229], v[50:51], v[22:23] op_sel:[0,1] op_sel_hi:[1,1]
    v_pk_fma_f32 v[210:211], v[210:211], v[22:23], v[228:229] op_sel:[0,0,0] op_sel_hi:[1,0,1]
    v_cvt_pk_bf16_f32 v238, v208, v209
    v_cvt_pk_bf16_f32 v239, v210, v211
    buffer_store_dwordx4 v[236:239], v240, s[32:35], s63 offen offset:3072 sc1
K1_KV_E2:
    s_setprio 0
    v_bfe_u32 v5, v1, 2, 2
    v_and_b32 v6, 3, v1
    v_mul_u32_u24 v7, 800, v2
    v_mul_u32_u24 v5, 40, v5
    v_add_u32 v7, v7, v5
    v_add_u32 v7, 151040, v7
    v_mov_b32 v8, 155136
    v_cmp_eq_u32 vcc, v6, v2
    s_nop 1
    v_cndmask_b32 v7, v8, v7, vcc
    ds_read_b64_tr_b16 v[44:45], v7 offset:0
    ds_read_b64_tr_b16 v[46:47], v7 offset:160
    ds_read_b64_tr_b16 v[48:49], v7 offset:320
    ds_read_b64_tr_b16 v[50:51], v7 offset:480
    ds_read_b64_tr_b16 v[52:53], v7 offset:640
    v_mov_b32 v54, 0
    v_mov_b32 v55, 0
    ds_read_b64_tr_b16 v[56:57], v7 offset:8
    ds_read_b64_tr_b16 v[58:59], v7 offset:168
    ds_read_b64_tr_b16 v[60:61], v7 offset:328
    ds_read_b64_tr_b16 v[62:63], v7 offset:488
    ds_read_b64_tr_b16 v[64:65], v7 offset:648
    v_mov_b32 v66, 0
    v_mov_b32 v67, 0
    ds_read_b64_tr_b16 v[68:69], v7 offset:16
    ds_read_b64_tr_b16 v[70:71], v7 offset:176
    ds_read_b64_tr_b16 v[72:73], v7 offset:336
    ds_read_b64_tr_b16 v[74:75], v7 offset:496
    ds_read_b64_tr_b16 v[76:77], v7 offset:656
    v_mov_b32 v78, 0
    v_mov_b32 v79, 0
    ds_read_b64_tr_b16 v[80:81], v7 offset:24
    ds_read_b64_tr_b16 v[82:83], v7 offset:184
    ds_read_b64_tr_b16 v[84:85], v7 offset:344
    ds_read_b64_tr_b16 v[86:87], v7 offset:504
    ds_read_b64_tr_b16 v[88:89], v7 offset:664
    v_mov_b32 v90, 0
    v_mov_b32 v91, 0
    ds_read_b64_tr_b16 v[92:93], v7 offset:32
    ds_read_b64_tr_b16 v[94:95], v7 offset:192
    ds_read_b64_tr_b16 v[96:97], v7 offset:352
    ds_read_b64_tr_b16 v[98:99], v7 offset:512
    ds_read_b64_tr_b16 v[100:101], v7 offset:672
    v_mov_b32 v102, 0
    v_mov_b32 v103, 0
    s_mul_i32 s63, s44, 3328
    v_mul_u32_u24 v4, 208, v3
    v_mul_u32_u24 v5, 48, v2
    v_add_u32 v4, v4, v5
    v_add_u32 v4, s63, v4
    s_waitcnt lgkmcnt(0)
    s_barrier
    ds_read_b128 v[32:35], v4 offset:0
    ds_read_b128 v[36:39], v4 offset:16
    ds_read_b128 v[40:43], v4 offset:32
    s_waitcnt lgkmcnt(0)
    v_mfma_f32_16x16x32_bf16 v[104:107], v[44:47], v[32:35], 0
    v_mfma_f32_16x16x32_bf16 v[108:111], v[56:59], v[32:35], 0
    v_mfma_f32_16x16x32_bf16 v[112:115], v[68:71], v[32:35], 0
    v_mfma_f32_16x16x32_bf16 v[116:119], v[80:83], v[32:35], 0
    v_mfma_f32_16x16x32_bf16 v[120:123], v[92:95], v[32:35], 0
    v_mfma_f32_16x16x32_bf16 v[104:107], v[48:51], v[36:39], v[104:107]
    v_mfma_f32_16x16x32_bf16 v[108:111], v[60:63], v[36:39], v[108:111]
    v_mfma_f32_16x16x32_bf16 v[112:115], v[72:75], v[36:39], v[112:115]
    v_mfma_f32_16x16x32_bf16 v[116:119], v[84:87], v[36:39], v[116:119]
    v_mfma_f32_16x16x32_bf16 v[120:123], v[96:99], v[36:39], v[120:123]
    v_mfma_f32_16x16x32_bf16 v[104:107], v[52:55], v[40:43], v[104:107]
    v_mfma_f32_16x16x32_bf16 v[108:111], v[64:67], v[40:43], v[108:111]
    v_mfma_f32_16x16x32_bf16 v[112:115], v[76:79], v[40:43], v[112:115]
    v_mfma_f32_16x16x32_bf16 v[116:119], v[88:91], v[40:43], v[116:119]
    v_mfma_f32_16x16x32_bf16 v[120:123], v[100:103], v[40:43], v[120:123]
    s_nop 7
    v_max3_f32 v4, v104, v105, v106
    v_min3_f32 v5, v104, v105, v106
    v_max3_f32 v4, v4, v107, v108
    v_min3_f32 v5, v5, v107, v108
    v_max3_f32 v4, v4, v109, v110
    v_min3_f32 v5, v5, v109, v110
    v_max3_f32 v4, v4, v111, v112
    v_min3_f32 v5, v5, v111, v112
    v_max3_f32 v4, v4, v113, v114
    v_min3_f32 v5, v5, v113, v114
    v_max3_f32 v4, v4, v115, v116
    v_min3_f32 v5, v5, v115, v116
    v_max3_f32 v4, v4, v117, v118
    v_min3_f32 v5, v5, v117, v118
    v_max3_f32 v4, v4, v119, v120
    v_min3_f32 v5, v5, v119, v120
    v_max3_f32 v4, v4, v121, v122
    v_min3_f32 v5, v5, v121, v122
    v_max_f32 v4, v4, v123
    v_min_f32 v5, v5, v123
    v_mov_b32 v6, 0x3fb8aa3b
    v_mov_b32 v8, 0xbfb8aa3b
    v_mul_f32 v7, v8, v4
    v_mul_f32 v9, v6, v5
    v_fma_f32 v128, v104, v6, v7
    v_fma_f32 v148, v104, v8, v9
    v_fma_f32 v129, v105, v6, v7
    v_fma_f32 v149, v105, v8, v9
    v_fma_f32 v130, v106, v6, v7
    v_fma_f32 v150, v106, v8, v9
    v_fma_f32 v131, v107, v6, v7
    v_fma_f32 v151, v107, v8, v9
    v_fma_f32 v132, v108, v6, v7
    v_fma_f32 v152, v108, v8, v9
    v_fma_f32 v133, v109, v6, v7
    v_fma_f32 v153, v109, v8, v9
    v_fma_f32 v134, v110, v6, v7
    v_fma_f32 v154, v110, v8, v9
    v_fma_f32 v135, v111, v6, v7
    v_fma_f32 v155, v111, v8, v9
    v_fma_f32 v136, v112, v6, v7
    v_fma_f32 v156, v112, v8, v9
    v_fma_f32 v137, v113, v6, v7
    v_fma_f32 v157, v113, v8, v9
    v_fma_f32 v138, v114, v6, v7
    v_fma_f32 v158, v114, v8, v9
    v_fma_f32 v139, v115, v6, v7
    v_fma_f32 v159, v115, v8, v9
    v_fma_f32 v140, v116, v6, v7
    v_fma_f32 v160, v116, v8, v9
    v_fma_f32 v141, v117, v6, v7
    v_fma_f32 v161, v117, v8, v9
    v_fma_f32 v142, v118, v6, v7
    v_fma_f32 v162, v118, v8, v9
    v_fma_f32 v143, v119, v6, v7
    v_fma_f32 v163, v119, v8, v9
    v_fma_f32 v144, v120, v6, v7
    v_fma_f32 v164, v120, v8, v9
    v_fma_f32 v145, v121, v6, v7
    v_fma_f32 v165, v121, v8, v9
    v_fma_f32 v146, v122, v6, v7
    v_fma_f32 v166, v122, v8, v9
    v_fma_f32 v147, v123, v6, v7
    v_fma_f32 v167, v123, v8, v9
    v_exp_f32 v128, v128
    v_exp_f32 v129, v129
    v_exp_f32 v130, v130
    v_exp_f32 v131, v131
    v_exp_f32 v132, v132
    v_exp_f32 v133, v133
    v_exp_f32 v134, v134
    v_exp_f32 v135, v135
    v_exp_f32 v136, v136
    v_exp_f32 v137, v137
    v_exp_f32 v138, v138
    v_exp_f32 v139, v139
    v_exp_f32 v140, v140
    v_exp_f32 v141, v141
    v_exp_f32 v142, v142
    v_exp_f32 v143, v143
    v_exp_f32 v144, v144
    v_exp_f32 v145, v145
    v_exp_f32 v146, v146
    v_exp_f32 v147, v147
    v_exp_f32 v148, v148
    v_exp_f32 v149, v149
    v_exp_f32 v150, v150
    v_exp_f32 v151, v151
    v_exp_f32 v152, v152
    v_exp_f32 v153, v153
    v_exp_f32 v154, v154
    v_exp_f32 v155, v155
    v_exp_f32 v156, v156
    v_exp_f32 v157, v157
    v_exp_f32 v158, v158
    v_exp_f32 v159, v159
    v_exp_f32 v160, v160
    v_exp_f32 v161, v161
    v_exp_f32 v162, v162
    v_exp_f32 v163, v163
    v_exp_f32 v164, v164
    v_exp_f32 v165, v165
    v_exp_f32 v166, v166
    v_exp_f32 v167, v167
    s_nop 0
    v_add_f32 v4, v128, v129
    v_add_f32 v5, v130, v131
    v_add_f32 v4, v4, v132
    v_add_f32 v5, v5, v133
    v_add_f32 v4, v4, v134
    v_add_f32 v5, v5, v135
    v_add_f32 v4, v4, v136
    v_add_f32 v5, v5, v137
    v_add_f32 v4, v4, v138
    v_add_f32 v5, v5, v139
    v_add_f32 v4, v4, v140
    v_add_f32 v5, v5, v141
    v_add_f32 v4, v4, v142
    v_add_f32 v5, v5, v143
    v_add_f32 v4, v4, v144
    v_add_f32 v5, v5, v145
    v_add_f32 v4, v4, v146
    v_add_f32 v5, v5, v147
    v_add_f32 v4, v4, v5
    v_add_f32 v10, v148, v149
    v_add_f32 v11, v150, v151
    v_add_f32 v10, v10, v152
    v_add_f32 v11, v11, v153
    v_add_f32 v10, v10, v154
    v_add_f32 v11, v11, v155
    v_add_f32 v10, v10, v156
    v_add_f32 v11, v11, v157
    v_add_f32 v10, v10, v158
    v_add_f32 v11, v11, v159
    v_add_f32 v10, v10, v160
    v_add_f32 v11, v11, v161
    v_add_f32 v10, v10, v162
    v_add_f32 v11, v11, v163
    v_add_f32 v10, v10, v164
    v_add_f32 v11, v11, v165
    v_add_f32 v10, v10, v166
    v_add_f32 v11, v11, v167
    v_add_f32 v10, v10, v11
    v_rcp_f32 v4, v4
    v_rcp_f32 v10, v10
    s_nop 0
    v_mul_f32 v128, v128, v4
    v_mul_f32 v129, v129, v4
    v_cvt_pk_bf16_f32 v168, v128, v129
    v_mul_f32 v130, v130, v4
    v_mul_f32 v131, v131, v4
    v_cvt_pk_bf16_f32 v169, v130, v131
    v_mul_f32 v132, v132, v4
    v_mul_f32 v133, v133, v4
    v_cvt_pk_bf16_f32 v170, v132, v133
    v_mul_f32 v134, v134, v4
    v_mul_f32 v135, v135, v4
    v_cvt_pk_bf16_f32 v171, v134, v135
    v_mul_f32 v136, v136, v4
    v_mul_f32 v137, v137, v4
    v_cvt_pk_bf16_f32 v172, v136, v137
    v_mul_f32 v138, v138, v4
    v_mul_f32 v139, v139, v4
    v_cvt_pk_bf16_f32 v173, v138, v139
    v_mul_f32 v140, v140, v4
    v_mul_f32 v141, v141, v4
    v_cvt_pk_bf16_f32 v174, v140, v141
    v_mul_f32 v142, v142, v4
    v_mul_f32 v143, v143, v4
    v_cvt_pk_bf16_f32 v175, v142, v143
    v_mul_f32 v144, v144, v4
    v_mul_f32 v145, v145, v4
    v_cvt_pk_bf16_f32 v176, v144, v145
    v_mul_f32 v146, v146, v4
    v_mul_f32 v147, v147, v4
    v_cvt_pk_bf16_f32 v177, v146, v147
    v_mul_f32 v148, v148, v10
    v_mul_f32 v149, v149, v10
    v_cvt_pk_bf16_f32 v178, v148, v149
    v_mul_f32 v150, v150, v10
    v_mul_f32 v151, v151, v10
    v_cvt_pk_bf16_f32 v179, v150, v151
    v_mul_f32 v152, v152, v10
    v_mul_f32 v153, v153, v10
    v_cvt_pk_bf16_f32 v180, v152, v153
    v_mul_f32 v154, v154, v10
    v_mul_f32 v155, v155, v10
    v_cvt_pk_bf16_f32 v181, v154, v155
    v_mul_f32 v156, v156, v10
    v_mul_f32 v157, v157, v10
    v_cvt_pk_bf16_f32 v182, v156, v157
    v_mul_f32 v158, v158, v10
    v_mul_f32 v159, v159, v10
    v_cvt_pk_bf16_f32 v183, v158, v159
    v_mul_f32 v160, v160, v10
    v_mul_f32 v161, v161, v10
    v_cvt_pk_bf16_f32 v184, v160, v161
    v_mul_f32 v162, v162, v10
    v_mul_f32 v163, v163, v10
    v_cvt_pk_bf16_f32 v185, v162, v163
    v_mul_f32 v164, v164, v10
    v_mul_f32 v165, v165, v10
    v_cvt_pk_bf16_f32 v186, v164, v165
    v_mul_f32 v166, v166, v10
    v_mul_f32 v167, v167, v10
    v_cvt_pk_bf16_f32 v187, v166, v167
    s_mul_i32 s63, s44, 5376
    v_mul_u32_u24 v4, 336, v3
    v_mul_u32_u24 v5, 80, v2
    v_add_u32 v4, v4, v5
    v_add_u32 v4, s63, v4
    ds_write_b128 v4, v[168:171] offset:53248
    ds_write_b128 v4, v[172:175] offset:53264
    ds_write_b128 v4, v[176:179] offset:53280
    ds_write_b128 v4, v[180:183] offset:53296
    ds_write_b128 v4, v[184:187] offset:53312
    s_waitcnt lgkmcnt(0)
    s_barrier
    s_lshr_b32 s63, s44, 1
    s_and_b32 s64, s44, 1
    v_bfe_u32 v5, v1, 2, 2
    v_and_b32 v6, 3, v1
    v_lshl_add_u32 v5, v2, 3, v5
    v_mul_u32_u24 v7, 336, v5
    v_lshl_add_u32 v7, v6, 3, v7
    s_mul_i32 s65, s63, 80
    s_add_u32 s65, s65, 53248
    v_add_u32 v7, s65, v7
    v_mul_u32_u24 v8, 208, v5
    v_lshl_add_u32 v8, v6, 3, v8
    s_mul_i32 s65, s63, 48
    s_lshl_b32 s66, s64, 5
    s_add_u32 s65, s65, s66
    v_add_u32 v8, s65, v8
    ds_read_b64_tr_b16 v[80:81], v8 offset:26624
    ds_read_b64_tr_b16 v[82:83], v8 offset:27456
    ds_read_b64_tr_b16 v[32:33], v7 offset:0
    ds_read_b64_tr_b16 v[34:35], v7 offset:1344
    ds_read_b64_tr_b16 v[36:37], v7 offset:32
    ds_read_b64_tr_b16 v[38:39], v7 offset:1376
    ds_read_b64_tr_b16 v[40:41], v7 offset:64
    ds_read_b64_tr_b16 v[42:43], v7 offset:1408
    ds_read_b64_tr_b16 v[84:85], v8 offset:33280
    ds_read_b64_tr_b16 v[86:87], v8 offset:34112
    ds_read_b64_tr_b16 v[44:45], v7 offset:10752
    ds_read_b64_tr_b16 v[46:47], v7 offset:12096
    ds_read_b64_tr_b16 v[48:49], v7 offset:10784
    ds_read_b64_tr_b16 v[50:51], v7 offset:12128
    ds_read_b64_tr_b16 v[52:53], v7 offset:10816
    ds_read_b64_tr_b16 v[54:55], v7 offset:12160
    ds_read_b64_tr_b16 v[88:89], v8 offset:39936
    ds_read_b64_tr_b16 v[90:91], v8 offset:40768
    ds_read_b64_tr_b16 v[56:57], v7 offset:21504
    ds_read_b64_tr_b16 v[58:59], v7 offset:22848
    ds_read_b64_tr_b16 v[60:61], v7 offset:21536
    ds_read_b64_tr_b16 v[62:63], v7 offset:22880
    ds_read_b64_tr_b16 v[64:65], v7 offset:21568
    ds_read_b64_tr_b16 v[66:67], v7 offset:22912
    ds_read_b64_tr_b16 v[92:93], v8 offset:46592
    ds_read_b64_tr_b16 v[94:95], v8 offset:47424
    ds_read_b64_tr_b16 v[68:69], v7 offset:32256
    ds_read_b64_tr_b16 v[70:71], v7 offset:33600
    ds_read_b64_tr_b16 v[72:73], v7 offset:32288
    ds_read_b64_tr_b16 v[74:75], v7 offset:33632
    ds_read_b64_tr_b16 v[76:77], v7 offset:32320
    ds_read_b64_tr_b16 v[78:79], v7 offset:33664
    s_waitcnt lgkmcnt(0)
    v_mfma_f32_16x16x32_bf16 v[104:107], v[32:35], v[80:83], 0
    v_mfma_f32_16x16x32_bf16 v[108:111], v[36:39], v[80:83], 0
    v_mfma_f32_16x16x32_bf16 v[112:115], v[40:43], v[80:83], 0
    v_mfma_f32_16x16x32_bf16 v[104:107], v[44:47], v[84:87], v[104:107]
    v_mfma_f32_16x16x32_bf16 v[108:111], v[48:51], v[84:87], v[108:111]
    v_mfma_f32_16x16x32_bf16 v[112:115], v[52:55], v[84:87], v[112:115]
    v_mfma_f32_16x16x32_bf16 v[104:107], v[56:59], v[88:91], v[104:107]
    v_mfma_f32_16x16x32_bf16 v[108:111], v[60:63], v[88:91], v[108:111]
    v_mfma_f32_16x16x32_bf16 v[112:115], v[64:67], v[88:91], v[112:115]
    v_mfma_f32_16x16x32_bf16 v[104:107], v[68:71], v[92:95], v[104:107]
    v_mfma_f32_16x16x32_bf16 v[108:111], v[72:75], v[92:95], v[108:111]
    v_mfma_f32_16x16x32_bf16 v[112:115], v[76:79], v[92:95], v[112:115]
    s_lshl_b32 s65, s64, 4
    v_add_u32 v5, s65, v3
    v_mul_u32_u24 v6, 80, v5
    v_lshl_add_u32 v6, v2, 3, v6
    v_mov_b32 v9, 2147483632
    v_cmp_ge_u32 vcc, 20, v5
    s_nop 1
    v_cndmask_b32 v6, v9, v6, vcc
    v_cmp_gt_u32 vcc, 2, v2
    s_nop 1
    v_cndmask_b32 v9, v9, v6, vcc
    s_lshl_b32 s65, s45, 5
    s_lshl_b32 s66, s46, 2
    s_add_u32 s65, s65, s66
    s_add_u32 s65, s65, s63
    s_mul_i32 s65, s65, 1792
    s_add_u32 s65, s65, 9699328
    s_nop 7
    v_cvt_pk_bf16_f32 v120, v104, v105
    v_cvt_pk_bf16_f32 v121, v106, v107
    v_cvt_pk_bf16_f32 v122, v108, v109
    v_cvt_pk_bf16_f32 v123, v110, v111
    v_cvt_pk_bf16_f32 v124, v112, v113
    v_cvt_pk_bf16_f32 v125, v114, v115
    buffer_store_dwordx2 v[120:121], v6, s[32:35], s65 offen offset:0 sc1
    buffer_store_dwordx2 v[122:123], v6, s[32:35], s65 offen offset:32 sc1
    buffer_store_dwordx2 v[124:125], v9, s[32:35], s65 offen offset:64 sc1
    s_branch K1_END
K1_P8:
    ds_read_b128 v[16:19], v10 offset:0
    ds_read_b128 v[20:23], v10 offset:2048
    ds_read_b128 v[24:27], v10 offset:4096
    ds_read_b128 v[28:31], v10 offset:6144
    ds_read_b64_tr_b16 v[48:49], v11 offset:0
    ds_read_b64_tr_b16 v[50:51], v11 offset:256
    ds_read_b64_tr_b16 v[52:53], v12 offset:0
    ds_read_b64_tr_b16 v[54:55], v12 offset:256
    ds_read_b64_tr_b16 v[56:57], v11 offset:512
    ds_read_b64_tr_b16 v[58:59], v11 offset:768
    ds_read_b64_tr_b16 v[60:61], v12 offset:512
    ds_read_b64_tr_b16 v[62:63], v12 offset:768
    ds_read_b64_tr_b16 v[64:65], v11 offset:4096
    ds_read_b64_tr_b16 v[66:67], v11 offset:4352
    ds_read_b64_tr_b16 v[68:69], v12 offset:4096
    ds_read_b64_tr_b16 v[70:71], v12 offset:4352
    ds_read_b64_tr_b16 v[72:73], v11 offset:4608
    ds_read_b64_tr_b16 v[74:75], v11 offset:4864
    ds_read_b64_tr_b16 v[76:77], v12 offset:4608
    ds_read_b64_tr_b16 v[78:79], v12 offset:4864
    s_cmp_eq_u32 s48, 0
    s_cbranch_scc0 K1_P8_B
K1_P8_LA:
    s_waitcnt lgkmcnt(14)
    s_add_u32 s59, s59, 1
    s_cmp_eq_u32 s59, 6
    s_cselect_b32 s58, s74, s73
    s_cselect_b32 s59, 0, s59
    v_mfma_f32_16x16x32_bf16 v[100:103], v[48:51], v[16:19], v[100:103]
    v_add_u32 v11, s58, v11
    v_add_u32 v12, s58, v12
    v_mfma_f32_16x16x32_bf16 v[104:107], v[48:51], v[20:23], v[104:107]
    v_mfma_f32_16x16x32_bf16 v[108:111], v[48:51], v[24:27], v[108:111]
    v_mfma_f32_16x16x32_bf16 v[112:115], v[48:51], v[28:31], v[112:115]
    s_barrier
    v_mfma_f32_16x16x32_bf16 v[84:87], v[48:51], v[80:83], v[84:87]
    s_waitcnt lgkmcnt(12)
    v_mfma_f32_16x16x32_bf16 v[116:119], v[52:55], v[16:19], v[116:119]
    ds_read_b128 v[32:35], v10 offset:512
    ds_read_b128 v[36:39], v10 offset:2560
    ds_read_b128 v[40:43], v10 offset:4608
    ds_read_b128 v[44:47], v10 offset:6656
    v_mfma_f32_16x16x32_bf16 v[120:123], v[52:55], v[20:23], v[120:123]
    ds_read_b64_tr_b16 v[48:49], v11 offset:0
    ds_read_b64_tr_b16 v[50:51], v11 offset:256
    v_mfma_f32_16x16x32_bf16 v[124:127], v[52:55], v[24:27], v[124:127]
    v_mfma_f32_16x16x32_bf16 v[128:131], v[52:55], v[28:31], v[128:131]
    v_mfma_f32_16x16x32_bf16 v[88:91], v[52:55], v[80:83], v[88:91]
    s_waitcnt lgkmcnt(15)
    v_mfma_f32_16x16x32_bf16 v[132:135], v[56:59], v[16:19], v[132:135]
    v_mfma_f32_16x16x32_bf16 v[136:139], v[56:59], v[20:23], v[136:139]
    ds_read_b64_tr_b16 v[52:53], v12 offset:0
    ds_read_b64_tr_b16 v[54:55], v12 offset:256
    v_mfma_f32_16x16x32_bf16 v[140:143], v[56:59], v[24:27], v[140:143]
    v_mfma_f32_16x16x32_bf16 v[144:147], v[56:59], v[28:31], v[144:147]
    v_mfma_f32_16x16x32_bf16 v[92:95], v[56:59], v[80:83], v[92:95]
    s_waitcnt lgkmcnt(15)
    v_mfma_f32_16x16x32_bf16 v[148:151], v[60:63], v[16:19], v[148:151]
    v_mfma_f32_16x16x32_bf16 v[152:155], v[60:63], v[20:23], v[152:155]
    ds_read_b64_tr_b16 v[56:57], v11 offset:512
    ds_read_b64_tr_b16 v[58:59], v11 offset:768
    v_mfma_f32_16x16x32_bf16 v[156:159], v[60:63], v[24:27], v[156:159]
    v_mfma_f32_16x16x32_bf16 v[160:163], v[60:63], v[28:31], v[160:163]
    v_mfma_f32_16x16x32_bf16 v[96:99], v[60:63], v[80:83], v[96:99]
    s_waitcnt lgkmcnt(15)
    v_mfma_f32_16x16x32_bf16 v[164:167], v[64:67], v[16:19], v[164:167]
    v_mfma_f32_16x16x32_bf16 v[168:171], v[64:67], v[20:23], v[168:171]
    ds_read_b64_tr_b16 v[60:61], v12 offset:512
    ds_read_b64_tr_b16 v[62:63], v12 offset:768
    v_mfma_f32_16x16x32_bf16 v[172:175], v[64:67], v[24:27], v[172:175]
    v_mfma_f32_16x16x32_bf16 v[176:179], v[64:67], v[28:31], v[176:179]
    s_waitcnt lgkmcnt(15)
    v_mfma_f32_16x16x32_bf16 v[180:183], v[68:71], v[16:19], v[180:183]
    v_mfma_f32_16x16x32_bf16 v[184:187], v[68:71], v[20:23], v[184:187]
    ds_read_b64_tr_b16 v[64:65], v11 offset:4096
    ds_read_b64_tr_b16 v[66:67], v11 offset:4352
    v_mfma_f32_16x16x32_bf16 v[188:191], v[68:71], v[24:27], v[188:191]
    v_mfma_f32_16x16x32_bf16 v[192:195], v[68:71], v[28:31], v[192:195]
    s_waitcnt lgkmcnt(15)
    v_mfma_f32_16x16x32_bf16 v[196:199], v[72:75], v[16:19], v[196:199]
    v_mfma_f32_16x16x32_bf16 v[200:203], v[72:75], v[20:23], v[200:203]
    ds_read_b64_tr_b16 v[68:69], v12 offset:4096
    ds_read_b64_tr_b16 v[70:71], v12 offset:4352
    v_mfma_f32_16x16x32_bf16 v[204:207], v[72:75], v[24:27], v[204:207]
    v_mfma_f32_16x16x32_bf16 v[208:211], v[72:75], v[28:31], v[208:211]
    s_waitcnt lgkmcnt(15)
    v_mfma_f32_16x16x32_bf16 v[212:215], v[76:79], v[16:19], v[212:215]
    v_mfma_f32_16x16x32_bf16 v[216:219], v[76:79], v[20:23], v[216:219]
    ds_read_b64_tr_b16 v[72:73], v11 offset:4608
    ds_read_b64_tr_b16 v[74:75], v11 offset:4864
    v_mfma_f32_16x16x32_bf16 v[220:223], v[76:79], v[24:27], v[220:223]
    v_mfma_f32_16x16x32_bf16 v[224:227], v[76:79], v[28:31], v[224:227]
    ds_read_b64_tr_b16 v[76:77], v12 offset:4608
    ds_read_b64_tr_b16 v[78:79], v12 offset:4864
    s_cmp_eq_u32 s50, 2
    s_cbranch_scc0 Lst_4
    s_waitcnt vmcnt(0)
Lst_4:
    s_waitcnt lgkmcnt(14)
    s_add_u32 s59, s59, 1
    s_cmp_eq_u32 s59, 6
    s_cselect_b32 s58, s74, s73
    s_cselect_b32 s59, 0, s59
    s_add_u32 s60, s60, 1
    s_cmp_eq_u32 s60, 3
    s_cselect_b32 s61, s75, s73
    s_cselect_b32 s60, 0, s60
    v_mfma_f32_16x16x32_bf16 v[100:103], v[48:51], v[32:35], v[100:103]
    v_add_u32 v11, s58, v11
    v_add_u32 v12, s58, v12
    v_mfma_f32_16x16x32_bf16 v[104:107], v[48:51], v[36:39], v[104:107]
    v_add_u32 v10, s61, v10
    v_mfma_f32_16x16x32_bf16 v[108:111], v[48:51], v[40:43], v[108:111]
    v_mfma_f32_16x16x32_bf16 v[112:115], v[48:51], v[44:47], v[112:115]
    s_barrier
    v_mfma_f32_16x16x32_bf16 v[84:87], v[48:51], v[80:83], v[84:87]
    s_waitcnt lgkmcnt(12)
    v_mfma_f32_16x16x32_bf16 v[116:119], v[52:55], v[32:35], v[116:119]
    ds_read_b128 v[16:19], v10 offset:0
    ds_read_b128 v[20:23], v10 offset:2048
    ds_read_b128 v[24:27], v10 offset:4096
    ds_read_b128 v[28:31], v10 offset:6144
    v_mfma_f32_16x16x32_bf16 v[120:123], v[52:55], v[36:39], v[120:123]
    ds_read_b64_tr_b16 v[48:49], v11 offset:0
    ds_read_b64_tr_b16 v[50:51], v11 offset:256
    v_mfma_f32_16x16x32_bf16 v[124:127], v[52:55], v[40:43], v[124:127]
    v_mfma_f32_16x16x32_bf16 v[128:131], v[52:55], v[44:47], v[128:131]
    v_mfma_f32_16x16x32_bf16 v[88:91], v[52:55], v[80:83], v[88:91]
    s_waitcnt lgkmcnt(15)
    v_mfma_f32_16x16x32_bf16 v[132:135], v[56:59], v[32:35], v[132:135]
    v_mfma_f32_16x16x32_bf16 v[136:139], v[56:59], v[36:39], v[136:139]
    ds_read_b64_tr_b16 v[52:53], v12 offset:0
    ds_read_b64_tr_b16 v[54:55], v12 offset:256
    v_mfma_f32_16x16x32_bf16 v[140:143], v[56:59], v[40:43], v[140:143]
    v_mfma_f32_16x16x32_bf16 v[144:147], v[56:59], v[44:47], v[144:147]
    v_mfma_f32_16x16x32_bf16 v[92:95], v[56:59], v[80:83], v[92:95]
    s_waitcnt lgkmcnt(15)
    v_mfma_f32_16x16x32_bf16 v[148:151], v[60:63], v[32:35], v[148:151]
    v_mfma_f32_16x16x32_bf16 v[152:155], v[60:63], v[36:39], v[152:155]
    ds_read_b64_tr_b16 v[56:57], v11 offset:512
    ds_read_b64_tr_b16 v[58:59], v11 offset:768
    v_mfma_f32_16x16x32_bf16 v[156:159], v[60:63], v[40:43], v[156:159]
    v_mfma_f32_16x16x32_bf16 v[160:163], v[60:63], v[44:47], v[160:163]
    v_mfma_f32_16x16x32_bf16 v[96:99], v[60:63], v[80:83], v[96:99]
    s_waitcnt lgkmcnt(15)
    v_mfma_f32_16x16x32_bf16 v[164:167], v[64:67], v[32:35], v[164:167]
    v_mfma_f32_16x16x32_bf16 v[168:171], v[64:67], v[36:39], v[168:171]
    ds_read_b64_tr_b16 v[60:61], v12 offset:512
    ds_read_b64_tr_b16 v[62:63], v12 offset:768
    v_mfma_f32_16x16x32_bf16 v[172:175], v[64:67], v[40:43], v[172:175]
    v_mfma_f32_16x16x32_bf16 v[176:179], v[64:67], v[44:47], v[176:179]
    s_waitcnt lgkmcnt(15)
    v_mfma_f32_16x16x32_bf16 v[180:183], v[68:71], v[32:35], v[180:183]
    v_mfma_f32_16x16x32_bf16 v[184:187], v[68:71], v[36:39], v[184:187]
    ds_read_b64_tr_b16 v[64:65], v11 offset:4096
    ds_read_b64_tr_b16 v[66:67], v11 offset:4352
    v_mfma_f32_16x16x32_bf16 v[188:191], v[68:71], v[40:43], v[188:191]
    v_mfma_f32_16x16x32_bf16 v[192:195], v[68:71], v[44:47], v[192:195]
    s_waitcnt lgkmcnt(15)
    v_mfma_f32_16x16x32_bf16 v[196:199], v[72:75], v[32:35], v[196:199]
    v_mfma_f32_16x16x32_bf16 v[200:203], v[72:75], v[36:39], v[200:203]
    ds_read_b64_tr_b16 v[68:69], v12 offset:4096
    ds_read_b64_tr_b16 v[70:71], v12 offset:4352
    v_mfma_f32_16x16x32_bf16 v[204:207], v[72:75], v[40:43], v[204:207]
    v_mfma_f32_16x16x32_bf16 v[208:211], v[72:75], v[44:47], v[208:211]
    s_waitcnt lgkmcnt(15)
    v_mfma_f32_16x16x32_bf16 v[212:215], v[76:79], v[32:35], v[212:215]
    v_mfma_f32_16x16x32_bf16 v[216:219], v[76:79], v[36:39], v[216:219]
    ds_read_b64_tr_b16 v[72:73], v11 offset:4608
    ds_read_b64_tr_b16 v[74:75], v11 offset:4864
    v_mfma_f32_16x16x32_bf16 v[220:223], v[76:79], v[40:43], v[220:223]
    v_mfma_f32_16x16x32_bf16 v[224:227], v[76:79], v[44:47], v[224:227]
    ds_read_b64_tr_b16 v[76:77], v12 offset:4608
    ds_read_b64_tr_b16 v[78:79], v12 offset:4864
    s_add_u32 s50, s50, 2
    s_cmp_lt_u32 s50, 20
    s_cbranch_scc1 K1_P8_LA
    s_waitcnt lgkmcnt(0)
    s_nop 7
    s_lshl_b32 s63, s49, 9
    s_add_u32 s63, s63, 148480
    v_lshl_add_u32 v4, v2, 4, s63
    v_mov_b32 v5, 149504
    v_cmp_eq_u32 vcc, 0, v3
    s_nop 1
    v_cndmask_b32 v5, v5, v4, vcc
    ds_write_b128 v5, v[84:87] offset:0
    ds_write_b128 v5, v[88:91] offset:64
    ds_write_b128 v5, v[92:95] offset:128
    ds_write_b128 v5, v[96:99] offset:192
    s_waitcnt lgkmcnt(0)
    s_barrier
    s_lshl_b32 s63, s48, 9
    s_add_u32 s63, s63, 147456
    v_lshl_add_u32 v5, v3, 3, s63
    ds_read_b64 v[16:17], v5 offset:0
    ds_read_b64 v[18:19], v5 offset:128
    ds_read_b64 v[20:21], v5 offset:256
    ds_read_b64 v[22:23], v5 offset:384
    ds_read_b128 v[24:27], v4 offset:0
    ds_read_b128 v[28:31], v4 offset:64
    ds_read_b128 v[32:35], v4 offset:128
    ds_read_b128 v[36:39], v4 offset:192
    ds_read_b128 v[40:43], v4 offset:256
    ds_read_b128 v[44:47], v4 offset:320
    ds_read_b128 v[48:51], v4 offset:384
    ds_read_b128 v[52:55], v4 offset:448
    s_waitcnt lgkmcnt(0)
    s_branch K1_P8_EPI
K1_P8_B:
K1_P8_LB:
    s_waitcnt lgkmcnt(14)
    s_add_u32 s59, s59, 1
    s_cmp_eq_u32 s59, 6
    s_cselect_b32 s58, s74, s73
    s_cselect_b32 s59, 0, s59
    v_mfma_f32_16x16x32_bf16 v[100:103], v[48:51], v[16:19], v[100:103]
    v_add_u32 v11, s58, v11
    v_add_u32 v12, s58, v12
    v_mfma_f32_16x16x32_bf16 v[104:107], v[48:51], v[20:23], v[104:107]
    v_mfma_f32_16x16x32_bf16 v[108:111], v[48:51], v[24:27], v[108:111]
    v_mfma_f32_16x16x32_bf16 v[112:115], v[48:51], v[28:31], v[112:115]
    s_barrier
    s_waitcnt lgkmcnt(12)
    v_mfma_f32_16x16x32_bf16 v[116:119], v[52:55], v[16:19], v[116:119]
    ds_read_b128 v[32:35], v10 offset:512
    ds_read_b128 v[36:39], v10 offset:2560
    ds_read_b128 v[40:43], v10 offset:4608
    ds_read_b128 v[44:47], v10 offset:6656
    v_mfma_f32_16x16x32_bf16 v[120:123], v[52:55], v[20:23], v[120:123]
    ds_read_b64_tr_b16 v[48:49], v11 offset:0
    ds_read_b64_tr_b16 v[50:51], v11 offset:256
    v_mfma_f32_16x16x32_bf16 v[124:127], v[52:55], v[24:27], v[124:127]
    v_mfma_f32_16x16x32_bf16 v[128:131], v[52:55], v[28:31], v[128:131]
    s_waitcnt lgkmcnt(15)
    v_mfma_f32_16x16x32_bf16 v[132:135], v[56:59], v[16:19], v[132:135]
    v_mfma_f32_16x16x32_bf16 v[136:139], v[56:59], v[20:23], v[136:139]
    ds_read_b64_tr_b16 v[52:53], v12 offset:0
    ds_read_b64_tr_b16 v[54:55], v12 offset:256
    v_mfma_f32_16x16x32_bf16 v[140:143], v[56:59], v[24:27], v[140:143]
    v_mfma_f32_16x16x32_bf16 v[144:147], v[56:59], v[28:31], v[144:147]
    s_waitcnt lgkmcnt(15)
    v_mfma_f32_16x16x32_bf16 v[148:151], v[60:63], v[16:19], v[148:151]
    v_mfma_f32_16x16x32_bf16 v[152:155], v[60:63], v[20:23], v[152:155]
    ds_read_b64_tr_b16 v[56:57], v11 offset:512
    ds_read_b64_tr_b16 v[58:59], v11 offset:768
    v_mfma_f32_16x16x32_bf16 v[156:159], v[60:63], v[24:27], v[156:159]
    v_mfma_f32_16x16x32_bf16 v[160:163], v[60:63], v[28:31], v[160:163]
    s_waitcnt lgkmcnt(15)
    v_mfma_f32_16x16x32_bf16 v[164:167], v[64:67], v[16:19], v[164:167]
    v_mfma_f32_16x16x32_bf16 v[168:171], v[64:67], v[20:23], v[168:171]
    ds_read_b64_tr_b16 v[60:61], v12 offset:512
    ds_read_b64_tr_b16 v[62:63], v12 offset:768
    v_mfma_f32_16x16x32_bf16 v[172:175], v[64:67], v[24:27], v[172:175]
    v_mfma_f32_16x16x32_bf16 v[176:179], v[64:67], v[28:31], v[176:179]
    v_mfma_f32_16x16x32_bf16 v[84:87], v[64:67], v[80:83], v[84:87]
    s_waitcnt lgkmcnt(15)
    v_mfma_f32_16x16x32_bf16 v[180:183], v[68:71], v[16:19], v[180:183]
    v_mfma_f32_16x16x32_bf16 v[184:187], v[68:71], v[20:23], v[184:187]
    ds_read_b64_tr_b16 v[64:65], v11 offset:4096
    ds_read_b64_tr_b16 v[66:67], v11 offset:4352
    v_mfma_f32_16x16x32_bf16 v[188:191], v[68:71], v[24:27], v[188:191]
    v_mfma_f32_16x16x32_bf16 v[192:195], v[68:71], v[28:31], v[192:195]
    v_mfma_f32_16x16x32_bf16 v[88:91], v[68:71], v[80:83], v[88:91]
    s_waitcnt lgkmcnt(15)
    v_mfma_f32_16x16x32_bf16 v[196:199], v[72:75], v[16:19], v[196:199]
    v_mfma_f32_16x16x32_bf16 v[200:203], v[72:75], v[20:23], v[200:203]
    ds_read_b64_tr_b16 v[68:69], v12 offset:4096
    ds_read_b64_tr_b16 v[70:71], v12 offset:4352
    v_mfma_f32_16x16x32_bf16 v[204:207], v[72:75], v[24:27], v[204:207]
    v_mfma_f32_16x16x32_bf16 v[208:211], v[72:75], v[28:31], v[208:211]
    v_mfma_f32_16x16x32_bf16 v[92:95], v[72:75], v[80:83], v[92:95]
    s_waitcnt lgkmcnt(15)
    v_mfma_f32_16x16x32_bf16 v[212:215], v[76:79], v[16:19], v[212:215]
    v_mfma_f32_16x16x32_bf16 v[216:219], v[76:79], v[20:23], v[216:219]
    ds_read_b64_tr_b16 v[72:73], v11 offset:4608
    ds_read_b64_tr_b16 v[74:75], v11 offset:4864
    v_mfma_f32_16x16x32_bf16 v[220:223], v[76:79], v[24:27], v[220:223]
    v_mfma_f32_16x16x32_bf16 v[224:227], v[76:79], v[28:31], v[224:227]
    v_mfma_f32_16x16x32_bf16 v[96:99], v[76:79], v[80:83], v[96:99]
    ds_read_b64_tr_b16 v[76:77], v12 offset:4608
    ds_read_b64_tr_b16 v[78:79], v12 offset:4864
    s_cmp_eq_u32 s50, 2
    s_cbranch_scc0 Lst_5
    s_waitcnt vmcnt(0)
Lst_5:
    s_waitcnt lgkmcnt(14)
    s_add_u32 s59, s59, 1
    s_cmp_eq_u32 s59, 6
    s_cselect_b32 s58, s74, s73
    s_cselect_b32 s59, 0, s59
    s_add_u32 s60, s60, 1
    s_cmp_eq_u32 s60, 3
    s_cselect_b32 s61, s75, s73
    s_cselect_b32 s60, 0, s60
    v_mfma_f32_16x16x32_bf16 v[100:103], v[48:51], v[32:35], v[100:103]
    v_add_u32 v11, s58, v11
    v_add_u32 v12, s58, v12
    v_mfma_f32_16x16x32_bf16 v[104:107], v[48:51], v[36:39], v[104:107]
    v_add_u32 v10, s61, v10
    v_mfma_f32_16x16x32_bf16 v[108:111], v[48:51], v[40:43], v[108:111]
    v_mfma_f32_16x16x32_bf16 v[112:115], v[48:51], v[44:47], v[112:115]
    s_barrier
    s_waitcnt lgkmcnt(12)
    v_mfma_f32_16x16x32_bf16 v[116:119], v[52:55], v[32:35], v[116:119]
    ds_read_b128 v[16:19], v10 offset:0
    ds_read_b128 v[20:23], v10 offset:2048
    ds_read_b128 v[24:27], v10 offset:4096
    ds_read_b128 v[28:31], v10 offset:6144
    v_mfma_f32_16x16x32_bf16 v[120:123], v[52:55], v[36:39], v[120:123]
    ds_read_b64_tr_b16 v[48:49], v11 offset:0
    ds_read_b64_tr_b16 v[50:51], v11 offset:256
    v_mfma_f32_16x16x32_bf16 v[124:127], v[52:55], v[40:43], v[124:127]
    v_mfma_f32_16x16x32_bf16 v[128:131], v[52:55], v[44:47], v[128:131]
    s_waitcnt lgkmcnt(15)
    v_mfma_f32_16x16x32_bf16 v[132:135], v[56:59], v[32:35], v[132:135]
    v_mfma_f32_16x16x32_bf16 v[136:139], v[56:59], v[36:39], v[136:139]
    ds_read_b64_tr_b16 v[52:53], v12 offset:0
    ds_read_b64_tr_b16 v[54:55], v12 offset:256
    v_mfma_f32_16x16x32_bf16 v[140:143], v[56:59], v[40:43], v[140:143]
    v_mfma_f32_16x16x32_bf16 v[144:147], v[56:59], v[44:47], v[144:147]
    s_waitcnt lgkmcnt(15)
    v_mfma_f32_16x16x32_bf16 v[148:151], v[60:63], v[32:35], v[148:151]
    v_mfma_f32_16x16x32_bf16 v[152:155], v[60:63], v[36:39], v[152:155]
    ds_read_b64_tr_b16 v[56:57], v11 offset:512
    ds_read_b64_tr_b16 v[58:59], v11 offset:768
    v_mfma_f32_16x16x32_bf16 v[156:159], v[60:63], v[40:43], v[156:159]
    v_mfma_f32_16x16x32_bf16 v[160:163], v[60:63], v[44:47], v[160:163]
    s_waitcnt lgkmcnt(15)
    v_mfma_f32_16x16x32_bf16 v[164:167], v[64:67], v[32:35], v[164:167]
    v_mfma_f32_16x16x32_bf16 v[168:171], v[64:67], v[36:39], v[168:171]
    ds_read_b64_tr_b16 v[60:61], v12 offset:512
    ds_read_b64_tr_b16 v[62:63], v12 offset:768
    v_mfma_f32_16x16x32_bf16 v[172:175], v[64:67], v[40:43], v[172:175]
    v_mfma_f32_16x16x32_bf16 v[176:179], v[64:67], v[44:47], v[176:179]
    v_mfma_f32_16x16x32_bf16 v[84:87], v[64:67], v[80:83], v[84:87]
    s_waitcnt lgkmcnt(15)
    v_mfma_f32_16x16x32_bf16 v[180:183], v[68:71], v[32:35], v[180:183]
    v_mfma_f32_16x16x32_bf16 v[184:187], v[68:71], v[36:39], v[184:187]
    ds_read_b64_tr_b16 v[64:65], v11 offset:4096
    ds_read_b64_tr_b16 v[66:67], v11 offset:4352
    v_mfma_f32_16x16x32_bf16 v[188:191], v[68:71], v[40:43], v[188:191]
    v_mfma_f32_16x16x32_bf16 v[192:195], v[68:71], v[44:47], v[192:195]
    v_mfma_f32_16x16x32_bf16 v[88:91], v[68:71], v[80:83], v[88:91]
    s_waitcnt lgkmcnt(15)
    v_mfma_f32_16x16x32_bf16 v[196:199], v[72:75], v[32:35], v[196:199]
    v_mfma_f32_16x16x32_bf16 v[200:203], v[72:75], v[36:39], v[200:203]
    ds_read_b64_tr_b16 v[68:69], v12 offset:4096
    ds_read_b64_tr_b16 v[70:71], v12 offset:4352
    v_mfma_f32_16x16x32_bf16 v[204:207], v[72:75], v[40:43], v[204:207]
    v_mfma_f32_16x16x32_bf16 v[208:211], v[72:75], v[44:47], v[208:211]
    v_mfma_f32_16x16x32_bf16 v[92:95], v[72:75], v[80:83], v[92:95]
    s_waitcnt lgkmcnt(15)
    v_mfma_f32_16x16x32_bf16 v[212:215], v[76:79], v[32:35], v[212:215]
    v_mfma_f32_16x16x32_bf16 v[216:219], v[76:79], v[36:39], v[216:219]
    ds_read_b64_tr_b16 v[72:73], v11 offset:4608
    ds_read_b64_tr_b16 v[74:75], v11 offset:4864
    v_mfma_f32_16x16x32_bf16 v[220:223], v[76:79], v[40:43], v[220:223]
    v_mfma_f32_16x16x32_bf16 v[224:227], v[76:79], v[44:47], v[224:227]
    v_mfma_f32_16x16x32_bf16 v[96:99], v[76:79], v[80:83], v[96:99]
    ds_read_b64_tr_b16 v[76:77], v12 offset:4608
    ds_read_b64_tr_b16 v[78:79], v12 offset:4864
    s_add_u32 s50, s50, 2
    s_cmp_lt_u32 s50, 20
    s_cbranch_scc1 K1_P8_LB
    s_waitcnt lgkmcnt(0)
    s_nop 7
    s_lshl_b32 s63, s49, 9
    s_add_u32 s63, s63, 148480
    v_lshl_add_u32 v4, v2, 4, s63
    v_mov_b32 v5, 149504
    v_cmp_eq_u32 vcc, 0, v3
    s_nop 1
    v_cndmask_b32 v5, v5, v4, vcc
    ds_write_b128 v5, v[84:87] offset:256
    ds_write_b128 v5, v[88:91] offset:320
    ds_write_b128 v5, v[92:95] offset:384
    ds_write_b128 v5, v[96:99] offset:448
    s_waitcnt lgkmcnt(0)
    s_barrier
    s_lshl_b32 s63, s48, 9
    s_add_u32 s63, s63, 147456
    v_lshl_add_u32 v5, v3, 3, s63
    ds_read_b64 v[16:17], v5 offset:0
    ds_read_b64 v[18:19], v5 offset:128
    ds_read_b64 v[20:21], v5 offset:256
    ds_read_b64 v[22:23], v5 offset:384
    ds_read_b128 v[24:27], v4 offset:0
    ds_read_b128 v[28:31], v4 offset:64
    ds_read_b128 v[32:35], v4 offset:128
    ds_read_b128 v[36:39], v4 offset:192
    ds_read_b128 v[40:43], v4 offset:256
    ds_read_b128 v[44:47], v4 offset:320
    ds_read_b128 v[48:51], v4 offset:384
    ds_read_b128 v[52:55], v4 offset:448
    s_waitcnt lgkmcnt(0)
K1_P8_EPI:
    v_lshlrev_b32 v240, 4, v1
    s_lshl_b32 s70, s46, 2
    s_lshl_b32 s63, s49, 1
    s_add_u32 s70, s70, s63
    s_add_u32 s70, s70, 8
    s_cmp_lt_u32 s70, 10
    s_cbranch_scc1 K1_PQ_6
    s_cmp_lt_u32 s70, 37
    s_cbranch_scc0 K1_PD_7
    s_lshl_b32 s63, s70, 1
    s_sub_u32 s63, s63, 20
    s_lshl_b32 s64, s45, 1
    s_add_u32 s64, s64, s48
    s_mul_i32 s64, s64, 54
    s_add_u32 s63, s63, s64
    s_lshl_b32 s63, s63, 12
    s_add_u32 s64, s63, 4096
    v_pk_mul_f32 v[228:229], v[24:25], v[16:17] op_sel:[0,1] op_sel_hi:[1,1]
    v_pk_fma_f32 v[100:101], v[100:101], v[16:17], v[228:229] op_sel:[0,0,0] op_sel_hi:[1,0,1]
    v_pk_mul_f32 v[228:229], v[26:27], v[16:17] op_sel:[0,1] op_sel_hi:[1,1]
    v_pk_fma_f32 v[102:103], v[102:103], v[16:17], v[228:229] op_sel:[0,0,0] op_sel_hi:[1,0,1]
    v_cvt_pk_bf16_f32 v232, v100, v101
    v_cvt_pk_bf16_f32 v233, v102, v103
    v_pk_mul_f32 v[228:229], v[28:29], v[16:17] op_sel:[0,1] op_sel_hi:[1,1]
    v_pk_fma_f32 v[116:117], v[116:117], v[16:17], v[228:229] op_sel:[0,0,0] op_sel_hi:[1,0,1]
    v_pk_mul_f32 v[228:229], v[30:31], v[16:17] op_sel:[0,1] op_sel_hi:[1,1]
    v_pk_fma_f32 v[118:119], v[118:119], v[16:17], v[228:229] op_sel:[0,0,0] op_sel_hi:[1,0,1]
    v_cvt_pk_bf16_f32 v234, v116, v117
    v_cvt_pk_bf16_f32 v235, v118, v119
    v_pk_max_i16 v232, v232, 0
    v_pk_max_i16 v233, v233, 0
    v_pk_max_i16 v234, v234, 0
    v_pk_max_i16 v235, v235, 0
    buffer_store_dwordx4 v[232:235], v240, s[32:35], s63 offen offset:0 sc1
    v_pk_mul_f32 v[228:229], v[24:25], v[18:19] op_sel:[0,1] op_sel_hi:[1,1]
    v_pk_fma_f32 v[104:105], v[104:105], v[18:19], v[228:229] op_sel:[0,0,0] op_sel_hi:[1,0,1]
    v_pk_mul_f32 v[228:229], v[26:27], v[18:19] op_sel:[0,1] op_sel_hi:[1,1]
    v_pk_fma_f32 v[106:107], v[106:107], v[18:19], v[228:229] op_sel:[0,0,0] op_sel_hi:[1,0,1]
    v_cvt_pk_bf16_f32 v236, v104, v105
    v_cvt_pk_bf16_f32 v237, v106, v107
    v_pk_mul_f32 v[228:229], v[28:29], v[18:19] op_sel:[0,1] op_sel_hi:[1,1]
    v_pk_fma_f32 v[120:121], v[120:121], v[18:19], v[228:229] op_sel:[0,0,0] op_sel_hi:[1,0,1]
    v_pk_mul_f32 v[228:229], v[30:31], v[18:19] op_sel:[0,1] op_sel_hi:[1,1]
    v_pk_fma_f32 v[122:123], v[122:123], v[18:19], v[228:229] op_sel:[0,0,0] op_sel_hi:[1,0,1]
    v_cvt_pk_bf16_f32 v238, v120, v121
    v_cvt_pk_bf16_f32 v239, v122, v123
    v_pk_max_i16 v236, v236, 0
    v_pk_max_i16 v237, v237, 0
    v_pk_max_i16 v238, v238, 0
    v_pk_max_i16 v239, v239, 0
    buffer_store_dwordx4 v[236:239], v240, s[32:35], s63 offen offset:1024 sc1
    v_pk_mul_f32 v[228:229], v[24:25], v[20:21] op_sel:[0,1] op_sel_hi:[1,1]
    v_pk_fma_f32 v[108:109], v[108:109], v[20:21], v[228:229] op_sel:[0,0,0] op_sel_hi:[1,0,1]
    v_pk_mul_f32 v[228:229], v[26:27], v[20:21] op_sel:[0,1] op_sel_hi:[1,1]
    v_pk_fma_f32 v[110:111], v[110:111], v[20:21], v[228:229] op_sel:[0,0,0] op_sel_hi:[1,0,1]
    v_cvt_pk_bf16_f32 v232, v108, v109
    v_cvt_pk_bf16_f32 v233, v110, v111
    v_pk_mul_f32 v[228:229], v[28:29], v[20:21] op_sel:[0,1] op_sel_hi:[1,1]
    v_pk_fma_f32 v[124:125], v[124:125], v[20:21], v[228:229] op_sel:[0,0,0] op_sel_hi:[1,0,1]
    v_pk_mul_f32 v[228:229], v[30:31], v[20:21] op_sel:[0,1] op_sel_hi:[1,1]
    v_pk_fma_f32 v[126:127], v[126:127], v[20:21], v[228:229] op_sel:[0,0,0] op_sel_hi:[1,0,1]
    v_cvt_pk_bf16_f32 v234, v124, v125
    v_cvt_pk_bf16_f32 v235, v126, v127
    v_pk_max_i16 v232, v232, 0
    v_pk_max_i16 v233, v233, 0
    v_pk_max_i16 v234, v234, 0
    v_pk_max_i16 v235, v235, 0
    buffer_store_dwordx4 v[232:235], v240, s[32:35], s63 offen offset:2048 sc1
    v_pk_mul_f32 v[228:229], v[24:25], v[22:23] op_sel:[0,1] op_sel_hi:[1,1]
    v_pk_fma_f32 v[112:113], v[112:113], v[22:23], v[228:229] op_sel:[0,0,0] op_sel_hi:[1,0,1]
    v_pk_mul_f32 v[228:229], v[26:27], v[22:23] op_sel:[0,1] op_sel_hi:[1,1]
    v_pk_fma_f32 v[114:115], v[114:115], v[22:23], v[228:229] op_sel:[0,0,0] op_sel_hi:[1,0,1]
    v_cvt_pk_bf16_f32 v236, v112, v113
    v_cvt_pk_bf16_f32 v237, v114, v115
    v_pk_mul_f32 v[228:229], v[28:29], v[22:23] op_sel:[0,1] op_sel_hi:[1,1]
    v_pk_fma_f32 v[128:129], v[128:129], v[22:23], v[228:229] op_sel:[0,0,0] op_sel_hi:[1,0,1]
    v_pk_mul_f32 v[228:229], v[30:31], v[22:23] op_sel:[0,1] op_sel_hi:[1,1]
    v_pk_fma_f32 v[130:131], v[130:131], v[22:23], v[228:229] op_sel:[0,0,0] op_sel_hi:[1,0,1]
    v_cvt_pk_bf16_f32 v238, v128, v129
    v_cvt_pk_bf16_f32 v239, v130, v131
    v_pk_max_i16 v236, v236, 0
    v_pk_max_i16 v237, v237, 0
    v_pk_max_i16 v238, v238, 0
    v_pk_max_i16 v239, v239, 0
    buffer_store_dwordx4 v[236:239], v240, s[32:35], s63 offen offset:3072 sc1
    v_pk_mul_f32 v[228:229], v[32:33], v[16:17] op_sel:[0,1] op_sel_hi:[1,1]
    v_pk_fma_f32 v[132:133], v[132:133], v[16:17], v[228:229] op_sel:[0,0,0] op_sel_hi:[1,0,1]
    v_pk_mul_f32 v[228:229], v[34:35], v[16:17] op_sel:[0,1] op_sel_hi:[1,1]
    v_pk_fma_f32 v[134:135], v[134:135], v[16:17], v[228:229] op_sel:[0,0,0] op_sel_hi:[1,0,1]
    v_cvt_pk_bf16_f32 v232, v132, v133
    v_cvt_pk_bf16_f32 v233, v134, v135
    v_pk_mul_f32 v[228:229], v[36:37], v[16:17] op_sel:[0,1] op_sel_hi:[1,1]
    v_pk_fma_f32 v[148:149], v[148:149], v[16:17], v[228:229] op_sel:[0,0,0] op_sel_hi:[1,0,1]
    v_pk_mul_f32 v[228:229], v[38:39], v[16:17] op_sel:[0,1] op_sel_hi:[1,1]
    v_pk_fma_f32 v[150:151], v[150:151], v[16:17], v[228:229] op_sel:[0,0,0] op_sel_hi:[1,0,1]
    v_cvt_pk_bf16_f32 v234, v148, v149
    v_cvt_pk_bf16_f32 v235, v150, v151
    v_pk_max_i16 v232, v232, 0
    v_pk_max_i16 v233, v233, 0
    v_pk_max_i16 v234, v234, 0
    v_pk_max_i16 v235, v235, 0
    buffer_store_dwordx4 v[232:235], v240, s[32:35], s64 offen offset:0 sc1
    v_pk_mul_f32 v[228:229], v[32:33], v[18:19] op_sel:[0,1] op_sel_hi:[1,1]
    v_pk_fma_f32 v[136:137], v[136:137], v[18:19], v[228:229] op_sel:[0,0,0] op_sel_hi:[1,0,1]
    v_pk_mul_f32 v[228:229], v[34:35], v[18:19] op_sel:[0,1] op_sel_hi:[1,1]
    v_pk_fma_f32 v[138:139], v[138:139], v[18:19], v[228:229] op_sel:[0,0,0] op_sel_hi:[1,0,1]
    v_cvt_pk_bf16_f32 v236, v136, v137
    v_cvt_pk_bf16_f32 v237, v138, v139
    v_pk_mul_f32 v[228:229], v[36:37], v[18:19] op_sel:[0,1] op_sel_hi:[1,1]
    v_pk_fma_f32 v[152:153], v[152:153], v[18:19], v[228:229] op_sel:[0,0,0] op_sel_hi:[1,0,1]
    v_pk_mul_f32 v[228:229], v[38:39], v[18:19] op_sel:[0,1] op_sel_hi:[1,1]
    v_pk_fma_f32 v[154:155], v[154:155], v[18:19], v[228:229] op_sel:[0,0,0] op_sel_hi:[1,0,1]
    v_cvt_pk_bf16_f32 v238, v152, v153
    v_cvt_pk_bf16_f32 v239, v154, v155
    v_pk_max_i16 v236, v236, 0
    v_pk_max_i16 v237, v237, 0
    v_pk_max_i16 v238, v238, 0
    v_pk_max_i16 v239, v239, 0
    buffer_store_dwordx4 v[236:239], v240, s[32:35], s64 offen offset:1024 sc1
    v_pk_mul_f32 v[228:229], v[32:33], v[20:21] op_sel:[0,1] op_sel_hi:[1,1]
    v_pk_fma_f32 v[140:141], v[140:141], v[20:21], v[228:229] op_sel:[0,0,0] op_sel_hi:[1,0,1]
    v_pk_mul_f32 v[228:229], v[34:35], v[20:21] op_sel:[0,1] op_sel_hi:[1,1]
    v_pk_fma_f32 v[142:143], v[142:143], v[20:21], v[228:229] op_sel:[0,0,0] op_sel_hi:[1,0,1]
    v_cvt_pk_bf16_f32 v232, v140, v141
    v_cvt_pk_bf16_f32 v233, v142, v143
    v_pk_mul_f32 v[228:229], v[36:37], v[20:21] op_sel:[0,1] op_sel_hi:[1,1]
    v_pk_fma_f32 v[156:157], v[156:157], v[20:21], v[228:229] op_sel:[0,0,0] op_sel_hi:[1,0,1]
    v_pk_mul_f32 v[228:229], v[38:39], v[20:21] op_sel:[0,1] op_sel_hi:[1,1]
    v_pk_fma_f32 v[158:159], v[158:159], v[20:21], v[228:229] op_sel:[0,0,0] op_sel_hi:[1,0,1]
    v_cvt_pk_bf16_f32 v234, v156, v157
    v_cvt_pk_bf16_f32 v235, v158, v159
    v_pk_max_i16 v232, v232, 0
    v_pk_max_i16 v233, v233, 0
    v_pk_max_i16 v234, v234, 0
    v_pk_max_i16 v235, v235, 0
    buffer_store_dwordx4 v[232:235], v240, s[32:35], s64 offen offset:2048 sc1
    v_pk_mul_f32 v[228:229], v[32:33], v[22:23] op_sel:[0,1] op_sel_hi:[1,1]
    v_pk_fma_f32 v[144:145], v[144:145], v[22:23], v[228:229] op_sel:[0,0,0] op_sel_hi:[1,0,1]
    v_pk_mul_f32 v[228:229], v[34:35], v[22:23] op_sel:[0,1] op_sel_hi:[1,1]
    v_pk_fma_f32 v[146:147], v[146:147], v[22:23], v[228:229] op_sel:[0,0,0] op_sel_hi:[1,0,1]
    v_cvt_pk_bf16_f32 v236, v144, v145
    v_cvt_pk_bf16_f32 v237, v146, v147
    v_pk_mul_f32 v[228:229], v[36:37], v[22:23] op_sel:[0,1] op_sel_hi:[1,1]
    v_pk_fma_f32 v[160:161], v[160:161], v[22:23], v[228:229] op_sel:[0,0,0] op_sel_hi:[1,0,1]
    v_pk_mul_f32 v[228:229], v[38:39], v[22:23] op_sel:[0,1] op_sel_hi:[1,1]
    v_pk_fma_f32 v[162:163], v[162:163], v[22:23], v[228:229] op_sel:[0,0,0] op_sel_hi:[1,0,1]
    v_cvt_pk_bf16_f32 v238, v160, v161
    v_cvt_pk_bf16_f32 v239, v162, v163
    v_pk_max_i16 v236, v236, 0
    v_pk_max_i16 v237, v237, 0
    v_pk_max_i16 v238, v238, 0
    v_pk_max_i16 v239, v239, 0
    buffer_store_dwordx4 v[236:239], v240, s[32:35], s64 offen offset:3072 sc1
    s_branch K1_PD_7
K1_PQ_6:
    s_lshl_b32 s63, s70, 1
    s_lshl_b32 s64, s45, 1
    s_add_u32 s64, s64, s48
    s_mul_i32 s64, s64, 20
    s_add_u32 s63, s63, s64
    s_lshl_b32 s63, s63, 12
    s_add_u32 s63, s63, 7077888
    s_add_u32 s64, s63, 4096
    v_pk_mul_f32 v[228:229], v[24:25], v[16:17] op_sel:[0,1] op_sel_hi:[1,1]
    v_pk_fma_f32 v[100:101], v[100:101], v[16:17], v[228:229] op_sel:[0,0,0] op_sel_hi:[1,0,1]
    v_pk_mul_f32 v[228:229], v[26:27], v[16:17] op_sel:[0,1] op_sel_hi:[1,1]
    v_pk_fma_f32 v[102:103], v[102:103], v[16:17], v[228:229] op_sel:[0,0,0] op_sel_hi:[1,0,1]
    v_cvt_pk_bf16_f32 v232, v100, v101
    v_cvt_pk_bf16_f32 v233, v102, v103
    v_pk_mul_f32 v[228:229], v[28:29], v[16:17] op_sel:[0,1] op_sel_hi:[1,1]
    v_pk_fma_f32 v[116:117], v[116:117], v[16:17], v[228:229] op_sel:[0,0,0] op_sel_hi:[1,0,1]
    v_pk_mul_f32 v[228:229], v[30:31], v[16:17] op_sel:[0,1] op_sel_hi:[1,1]
    v_pk_fma_f32 v[118:119], v[118:119], v[16:17], v[228:229] op_sel:[0,0,0] op_sel_hi:[1,0,1]
    v_cvt_pk_bf16_f32 v234, v116, v117
    v_cvt_pk_bf16_f32 v235, v118, v119
    buffer_store_dwordx4 v[232:235], v240, s[32:35], s63 offen offset:0 sc1
    v_pk_mul_f32 v[228:229], v[24:25], v[18:19] op_sel:[0,1] op_sel_hi:[1,1]
    v_pk_fma_f32 v[104:105], v[104:105], v[18:19], v[228:229] op_sel:[0,0,0] op_sel_hi:[1,0,1]
    v_pk_mul_f32 v[228:229], v[26:27], v[18:19] op_sel:[0,1] op_sel_hi:[1,1]
    v_pk_fma_f32 v[106:107], v[106:107], v[18:19], v[228:229] op_sel:[0,0,0] op_sel_hi:[1,0,1]
    v_cvt_pk_bf16_f32 v236, v104, v105
    v_cvt_pk_bf16_f32 v237, v106, v107
    v_pk_mul_f32 v[228:229], v[28:29], v[18:19] op_sel:[0,1] op_sel_hi:[1,1]
    v_pk_fma_f32 v[120:121], v[120:121], v[18:19], v[228:229] op_sel:[0,0,0] op_sel_hi:[1,0,1]
    v_pk_mul_f32 v[228:229], v[30:31], v[18:19] op_sel:[0,1] op_sel_hi:[1,1]
    v_pk_fma_f32 v[122:123], v[122:123], v[18:19], v[228:229] op_sel:[0,0,0] op_sel_hi:[1,0,1]
    v_cvt_pk_bf16_f32 v238, v120, v121
    v_cvt_pk_bf16_f32 v239, v122, v123
    buffer_store_dwordx4 v[236:239], v240, s[32:35], s63 offen offset:1024 sc1
    v_pk_mul_f32 v[228:229], v[24:25], v[20:21] op_sel:[0,1] op_sel_hi:[1,1]
    v_pk_fma_f32 v[108:109], v[108:109], v[20:21], v[228:229] op_sel:[0,0,0] op_sel_hi:[1,0,1]
    v_pk_mul_f32 v[228:229], v[26:27], v[20:21] op_sel:[0,1] op_sel_hi:[1,1]
    v_pk_fma_f32 v[110:111], v[110:111], v[20:21], v[228:229] op_sel:[0,0,0] op_sel_hi:[1,0,1]
    v_cvt_pk_bf16_f32 v232, v108, v109
    v_cvt_pk_bf16_f32 v233, v110, v111
    v_pk_mul_f32 v[228:229], v[28:29], v[20:21] op_sel:[0,1] op_sel_hi:[1,1]
    v_pk_fma_f32 v[124:125], v[124:125], v[20:21], v[228:229] op_sel:[0,0,0] op_sel_hi:[1,0,1]
    v_pk_mul_f32 v[228:229], v[30:31], v[20:21] op_sel:[0,1] op_sel_hi:[1,1]
    v_pk_fma_f32 v[126:127], v[126:127], v[20:21], v[228:229] op_sel:[0,0,0] op_sel_hi:[1,0,1]
    v_cvt_pk_bf16_f32 v234, v124, v125
    v_cvt_pk_bf16_f32 v235, v126, v127
    buffer_store_dwordx4 v[232:235], v240, s[32:35], s63 offen offset:2048 sc1
    v_pk_mul_f32 v[228:229], v[24:25], v[22:23] op_sel:[0,1] op_sel_hi:[1,1]
    v_pk_fma_f32 v[112:113], v[112:113], v[22:23], v[228:229] op_sel:[0,0,0] op_sel_hi:[1,0,1]
    v_pk_mul_f32 v[228:229], v[26:27], v[22:23] op_sel:[0,1] op_sel_hi:[1,1]
    v_pk_fma_f32 v[114:115], v[114:115], v[22:23], v[228:229] op_sel:[0,0,0] op_sel_hi:[1,0,1]
    v_cvt_pk_bf16_f32 v236, v112, v113
    v_cvt_pk_bf16_f32 v237, v114, v115
    v_pk_mul_f32 v[228:229], v[28:29], v[22:23] op_sel:[0,1] op_sel_hi:[1,1]
    v_pk_fma_f32 v[128:129], v[128:129], v[22:23], v[228:229] op_sel:[0,0,0] op_sel_hi:[1,0,1]
    v_pk_mul_f32 v[228:229], v[30:31], v[22:23] op_sel:[0,1] op_sel_hi:[1,1]
    v_pk_fma_f32 v[130:131], v[130:131], v[22:23], v[228:229] op_sel:[0,0,0] op_sel_hi:[1,0,1]
    v_cvt_pk_bf16_f32 v238, v128, v129
    v_cvt_pk_bf16_f32 v239, v130, v131
    buffer_store_dwordx4 v[236:239], v240, s[32:35], s63 offen offset:3072 sc1
    v_pk_mul_f32 v[228:229], v[32:33], v[16:17] op_sel:[0,1] op_sel_hi:[1,1]
    v_pk_fma_f32 v[132:133], v[132:133], v[16:17], v[228:229] op_sel:[0,0,0] op_sel_hi:[1,0,1]
    v_pk_mul_f32 v[228:229], v[34:35], v[16:17] op_sel:[0,1] op_sel_hi:[1,1]
    v_pk_fma_f32 v[134:135], v[134:135], v[16:17], v[228:229] op_sel:[0,0,0] op_sel_hi:[1,0,1]
    v_cvt_pk_bf16_f32 v232, v132, v133
    v_cvt_pk_bf16_f32 v233, v134, v135
    v_pk_mul_f32 v[228:229], v[36:37], v[16:17] op_sel:[0,1] op_sel_hi:[1,1]
    v_pk_fma_f32 v[148:149], v[148:149], v[16:17], v[228:229] op_sel:[0,0,0] op_sel_hi:[1,0,1]
    v_pk_mul_f32 v[228:229], v[38:39], v[16:17] op_sel:[0,1] op_sel_hi:[1,1]
    v_pk_fma_f32 v[150:151], v[150:151], v[16:17], v[228:229] op_sel:[0,0,0] op_sel_hi:[1,0,1]
    v_cvt_pk_bf16_f32 v234, v148, v149
    v_cvt_pk_bf16_f32 v235, v150, v151
    buffer_store_dwordx4 v[232:235], v240, s[32:35], s64 offen offset:0 sc1
    v_pk_mul_f32 v[228:229], v[32:33], v[18:19] op_sel:[0,1] op_sel_hi:[1,1]
    v_pk_fma_f32 v[136:137], v[136:137], v[18:19], v[228:229] op_sel:[0,0,0] op_sel_hi:[1,0,1]
    v_pk_mul_f32 v[228:229], v[34:35], v[18:19] op_sel:[0,1] op_sel_hi:[1,1]
    v_pk_fma_f32 v[138:139], v[138:139], v[18:19], v[228:229] op_sel:[0,0,0] op_sel_hi:[1,0,1]
    v_cvt_pk_bf16_f32 v236, v136, v137
    v_cvt_pk_bf16_f32 v237, v138, v139
    v_pk_mul_f32 v[228:229], v[36:37], v[18:19] op_sel:[0,1] op_sel_hi:[1,1]
    v_pk_fma_f32 v[152:153], v[152:153], v[18:19], v[228:229] op_sel:[0,0,0] op_sel_hi:[1,0,1]
    v_pk_mul_f32 v[228:229], v[38:39], v[18:19] op_sel:[0,1] op_sel_hi:[1,1]
    v_pk_fma_f32 v[154:155], v[154:155], v[18:19], v[228:229] op_sel:[0,0,0] op_sel_hi:[1,0,1]
    v_cvt_pk_bf16_f32 v238, v152, v153
    v_cvt_pk_bf16_f32 v239, v154, v155
    buffer_store_dwordx4 v[236:239], v240, s[32:35], s64 offen offset:1024 sc1
    v_pk_mul_f32 v[228:229], v[32:33], v[20:21] op_sel:[0,1] op_sel_hi:[1,1]
    v_pk_fma_f32 v[140:141], v[140:141], v[20:21], v[228:229] op_sel:[0,0,0] op_sel_hi:[1,0,1]
    v_pk_mul_f32 v[228:229], v[34:35], v[20:21] op_sel:[0,1] op_sel_hi:[1,1]
    v_pk_fma_f32 v[142:143], v[142:143], v[20:21], v[228:229] op_sel:[0,0,0] op_sel_hi:[1,0,1]
    v_cvt_pk_bf16_f32 v232, v140, v141
    v_cvt_pk_bf16_f32 v233, v142, v143
    v_pk_mul_f32 v[228:229], v[36:37], v[20:21] op_sel:[0,1] op_sel_hi:[1,1]
    v_pk_fma_f32 v[156:157], v[156:157], v[20:21], v[228:229] op_sel:[0,0,0] op_sel_hi:[1,0,1]
    v_pk_mul_f32 v[228:229], v[38:39], v[20:21] op_sel:[0,1] op_sel_hi:[1,1]
    v_pk_fma_f32 v[158:159], v[158:159], v[20:21], v[228:229] op_sel:[0,0,0] op_sel_hi:[1,0,1]
    v_cvt_pk_bf16_f32 v234, v156, v157
    v_cvt_pk_bf16_f32 v235, v158, v159
    buffer_store_dwordx4 v[232:235], v240, s[32:35], s64 offen offset:2048 sc1
    v_pk_mul_f32 v[228:229], v[32:33], v[22:23] op_sel:[0,1] op_sel_hi:[1,1]
    v_pk_fma_f32 v[144:145], v[144:145], v[22:23], v[228:229] op_sel:[0,0,0] op_sel_hi:[1,0,1]
    v_pk_mul_f32 v[228:229], v[34:35], v[22:23] op_sel:[0,1] op_sel_hi:[1,1]
    v_pk_fma_f32 v[146:147], v[146:147], v[22:23], v[228:229] op_sel:[0,0,0] op_sel_hi:[1,0,1]
    v_cvt_pk_bf16_f32 v236, v144, v145
    v_cvt_pk_bf16_f32 v237, v146, v147
    v_pk_mul_f32 v[228:229], v[36:37], v[22:23] op_sel:[0,1] op_sel_hi:[1,1]
    v_pk_fma_f32 v[160:161], v[160:161], v[22:23], v[228:229] op_sel:[0,0,0] op_sel_hi:[1,0,1]
    v_pk_mul_f32 v[228:229], v[38:39], v[22:23] op_sel:[0,1] op_sel_hi:[1,1]
    v_pk_fma_f32 v[162:163], v[162:163], v[22:23], v[228:229] op_sel:[0,0,0] op_sel_hi:[1,0,1]
    v_cvt_pk_bf16_f32 v238, v160, v161
    v_cvt_pk_bf16_f32 v239, v162, v163
    buffer_store_dwordx4 v[236:239], v240, s[32:35], s64 offen offset:3072 sc1
K1_PD_7:
    s_lshl_b32 s70, s46, 2
    s_lshl_b32 s63, s49, 1
    s_add_u32 s70, s70, s63
    s_add_u32 s70, s70, 9
    s_cmp_lt_u32 s70, 10
    s_cbranch_scc1 K1_PQ_8
    s_cmp_lt_u32 s70, 37
    s_cbranch_scc0 K1_PD_9
    s_lshl_b32 s63, s70, 1
    s_sub_u32 s63, s63, 20
    s_lshl_b32 s64, s45, 1
    s_add_u32 s64, s64, s48
    s_mul_i32 s64, s64, 54
    s_add_u32 s63, s63, s64
    s_lshl_b32 s63, s63, 12
    s_add_u32 s64, s63, 4096
    v_pk_mul_f32 v[228:229], v[40:41], v[16:17] op_sel:[0,1] op_sel_hi:[1,1]
    v_pk_fma_f32 v[164:165], v[164:165], v[16:17], v[228:229] op_sel:[0,0,0] op_sel_hi:[1,0,1]
    v_pk_mul_f32 v[228:229], v[42:43], v[16:17] op_sel:[0,1] op_sel_hi:[1,1]
    v_pk_fma_f32 v[166:167], v[166:167], v[16:17], v[228:229] op_sel:[0,0,0] op_sel_hi:[1,0,1]
    v_cvt_pk_bf16_f32 v232, v164, v165
    v_cvt_pk_bf16_f32 v233, v166, v167
    v_pk_mul_f32 v[228:229], v[44:45], v[16:17] op_sel:[0,1] op_sel_hi:[1,1]
    v_pk_fma_f32 v[180:181], v[180:181], v[16:17], v[228:229] op_sel:[0,0,0] op_sel_hi:[1,0,1]
    v_pk_mul_f32 v[228:229], v[46:47], v[16:17] op_sel:[0,1] op_sel_hi:[1,1]
    v_pk_fma_f32 v[182:183], v[182:183], v[16:17], v[228:229] op_sel:[0,0,0] op_sel_hi:[1,0,1]
    v_cvt_pk_bf16_f32 v234, v180, v181
    v_cvt_pk_bf16_f32 v235, v182, v183
    v_pk_max_i16 v232, v232, 0
    v_pk_max_i16 v233, v233, 0
    v_pk_max_i16 v234, v234, 0
    v_pk_max_i16 v235, v235, 0
    buffer_store_dwordx4 v[232:235], v240, s[32:35], s63 offen offset:0 sc1
    v_pk_mul_f32 v[228:229], v[40:41], v[18:19] op_sel:[0,1] op_sel_hi:[1,1]
    v_pk_fma_f32 v[168:169], v[168:169], v[18:19], v[228:229] op_sel:[0,0,0] op_sel_hi:[1,0,1]
    v_pk_mul_f32 v[228:229], v[42:43], v[18:19] op_sel:[0,1] op_sel_hi:[1,1]
    v_pk_fma_f32 v[170:171], v[170:171], v[18:19], v[228:229] op_sel:[0,0,0] op_sel_hi:[1,0,1]
    v_cvt_pk_bf16_f32 v236, v168, v169
    v_cvt_pk_bf16_f32 v237, v170, v171
    v_pk_mul_f32 v[228:229], v[44:45], v[18:19] op_sel:[0,1] op_sel_hi:[1,1]
    v_pk_fma_f32 v[184:185], v[184:185], v[18:19], v[228:229] op_sel:[0,0,0] op_sel_hi:[1,0,1]
    v_pk_mul_f32 v[228:229], v[46:47], v[18:19] op_sel:[0,1] op_sel_hi:[1,1]
    v_pk_fma_f32 v[186:187], v[186:187], v[18:19], v[228:229] op_sel:[0,0,0] op_sel_hi:[1,0,1]
    v_cvt_pk_bf16_f32 v238, v184, v185
    v_cvt_pk_bf16_f32 v239, v186, v187
    v_pk_max_i16 v236, v236, 0
    v_pk_max_i16 v237, v237, 0
    v_pk_max_i16 v238, v238, 0
    v_pk_max_i16 v239, v239, 0
    buffer_store_dwordx4 v[236:239], v240, s[32:35], s63 offen offset:1024 sc1
    v_pk_mul_f32 v[228:229], v[40:41], v[20:21] op_sel:[0,1] op_sel_hi:[1,1]
    v_pk_fma_f32 v[172:173], v[172:173], v[20:21], v[228:229] op_sel:[0,0,0] op_sel_hi:[1,0,1]
    v_pk_mul_f32 v[228:229], v[42:43], v[20:21] op_sel:[0,1] op_sel_hi:[1,1]
    v_pk_fma_f32 v[174:175], v[174:175], v[20:21], v[228:229] op_sel:[0,0,0] op_sel_hi:[1,0,1]
    v_cvt_pk_bf16_f32 v232, v172, v173
    v_cvt_pk_bf16_f32 v233, v174, v175
    v_pk_mul_f32 v[228:229], v[44:45], v[20:21] op_sel:[0,1] op_sel_hi:[1,1]
    v_pk_fma_f32 v[188:189], v[188:189], v[20:21], v[228:229] op_sel:[0,0,0] op_sel_hi:[1,0,1]
    v_pk_mul_f32 v[228:229], v[46:47], v[20:21] op_sel:[0,1] op_sel_hi:[1,1]
    v_pk_fma_f32 v[190:191], v[190:191], v[20:21], v[228:229] op_sel:[0,0,0] op_sel_hi:[1,0,1]
    v_cvt_pk_bf16_f32 v234, v188, v189
    v_cvt_pk_bf16_f32 v235, v190, v191
    v_pk_max_i16 v232, v232, 0
    v_pk_max_i16 v233, v233, 0
    v_pk_max_i16 v234, v234, 0
    v_pk_max_i16 v235, v235, 0
    buffer_store_dwordx4 v[232:235], v240, s[32:35], s63 offen offset:2048 sc1
    v_pk_mul_f32 v[228:229], v[40:41], v[22:23] op_sel:[0,1] op_sel_hi:[1,1]
    v_pk_fma_f32 v[176:177], v[176:177], v[22:23], v[228:229] op_sel:[0,0,0] op_sel_hi:[1,0,1]
    v_pk_mul_f32 v[228:229], v[42:43], v[22:23] op_sel:[0,1] op_sel_hi:[1,1]
    v_pk_fma_f32 v[178:179], v[178:179], v[22:23], v[228:229] op_sel:[0,0,0] op_sel_hi:[1,0,1]
    v_cvt_pk_bf16_f32 v236, v176, v177
    v_cvt_pk_bf16_f32 v237, v178, v179
    v_pk_mul_f32 v[228:229], v[44:45], v[22:23] op_sel:[0,1] op_sel_hi:[1,1]
    v_pk_fma_f32 v[192:193], v[192:193], v[22:23], v[228:229] op_sel:[0,0,0] op_sel_hi:[1,0,1]
    v_pk_mul_f32 v[228:229], v[46:47], v[22:23] op_sel:[0,1] op_sel_hi:[1,1]
    v_pk_fma_f32 v[194:195], v[194:195], v[22:23], v[228:229] op_sel:[0,0,0] op_sel_hi:[1,0,1]
    v_cvt_pk_bf16_f32 v238, v192, v193
    v_cvt_pk_bf16_f32 v239, v194, v195
    v_pk_max_i16 v236, v236, 0
    v_pk_max_i16 v237, v237, 0
    v_pk_max_i16 v238, v238, 0
    v_pk_max_i16 v239, v239, 0
    buffer_store_dwordx4 v[236:239], v240, s[32:35], s63 offen offset:3072 sc1
    v_pk_mul_f32 v[228:229], v[48:49], v[16:17] op_sel:[0,1] op_sel_hi:[1,1]
    v_pk_fma_f32 v[196:197], v[196:197], v[16:17], v[228:229] op_sel:[0,0,0] op_sel_hi:[1,0,1]
    v_pk_mul_f32 v[228:229], v[50:51], v[16:17] op_sel:[0,1] op_sel_hi:[1,1]
    v_pk_fma_f32 v[198:199], v[198:199], v[16:17], v[228:229] op_sel:[0,0,0] op_sel_hi:[1,0,1]
    v_cvt_pk_bf16_f32 v232, v196, v197
    v_cvt_pk_bf16_f32 v233, v198, v199
    v_pk_mul_f32 v[228:229], v[52:53], v[16:17] op_sel:[0,1] op_sel_hi:[1,1]
    v_pk_fma_f32 v[212:213], v[212:213], v[16:17], v[228:229] op_sel:[0,0,0] op_sel_hi:[1,0,1]
    v_pk_mul_f32 v[228:229], v[54:55], v[16:17] op_sel:[0,1] op_sel_hi:[1,1]
    v_pk_fma_f32 v[214:215], v[214:215], v[16:17], v[228:229] op_sel:[0,0,0] op_sel_hi:[1,0,1]
    v_cvt_pk_bf16_f32 v234, v212, v213
    v_cvt_pk_bf16_f32 v235, v214, v215
    v_pk_max_i16 v232, v232, 0
    v_pk_max_i16 v233, v233, 0
    v_pk_max_i16 v234, v234, 0
    v_pk_max_i16 v235, v235, 0
    buffer_store_dwordx4 v[232:235], v240, s[32:35], s64 offen offset:0 sc1
    v_pk_mul_f32 v[228:229], v[48:49], v[18:19] op_sel:[0,1] op_sel_hi:[1,1]
    v_pk_fma_f32 v[200:201], v[200:201], v[18:19], v[228:229] op_sel:[0,0,0] op_sel_hi:[1,0,1]
    v_pk_mul_f32 v[228:229], v[50:51], v[18:19] op_sel:[0,1] op_sel_hi:[1,1]
    v_pk_fma_f32 v[202:203], v[202:203], v[18:19], v[228:229] op_sel:[0,0,0] op_sel_hi:[1,0,1]
    v_cvt_pk_bf16_f32 v236, v200, v201
    v_cvt_pk_bf16_f32 v237, v202, v203
    v_pk_mul_f32 v[228:229], v[52:53], v[18:19] op_sel:[0,1] op_sel_hi:[1,1]
    v_pk_fma_f32 v[216:217], v[216:217], v[18:19], v[228:229] op_sel:[0,0,0] op_sel_hi:[1,0,1]
    v_pk_mul_f32 v[228:229], v[54:55], v[18:19] op_sel:[0,1] op_sel_hi:[1,1]
    v_pk_fma_f32 v[218:219], v[218:219], v[18:19], v[228:229] op_sel:[0,0,0] op_sel_hi:[1,0,1]
    v_cvt_pk_bf16_f32 v238, v216, v217
    v_cvt_pk_bf16_f32 v239, v218, v219
    v_pk_max_i16 v236, v236, 0
    v_pk_max_i16 v237, v237, 0
    v_pk_max_i16 v238, v238, 0
    v_pk_max_i16 v239, v239, 0
    buffer_store_dwordx4 v[236:239], v240, s[32:35], s64 offen offset:1024 sc1
    v_pk_mul_f32 v[228:229], v[48:49], v[20:21] op_sel:[0,1] op_sel_hi:[1,1]
    v_pk_fma_f32 v[204:205], v[204:205], v[20:21], v[228:229] op_sel:[0,0,0] op_sel_hi:[1,0,1]
    v_pk_mul_f32 v[228:229], v[50:51], v[20:21] op_sel:[0,1] op_sel_hi:[1,1]
    v_pk_fma_f32 v[206:207], v[206:207], v[20:21], v[228:229] op_sel:[0,0,0] op_sel_hi:[1,0,1]
    v_cvt_pk_bf16_f32 v232, v204, v205
    v_cvt_pk_bf16_f32 v233, v206, v207
    v_pk_mul_f32 v[228:229], v[52:53], v[20:21] op_sel:[0,1] op_sel_hi:[1,1]
    v_pk_fma_f32 v[220:221], v[220:221], v[20:21], v[228:229] op_sel:[0,0,0] op_sel_hi:[1,0,1]
    v_pk_mul_f32 v[228:229], v[54:55], v[20:21] op_sel:[0,1] op_sel_hi:[1,1]
    v_pk_fma_f32 v[222:223], v[222:223], v[20:21], v[228:229] op_sel:[0,0,0] op_sel_hi:[1,0,1]
    v_cvt_pk_bf16_f32 v234, v220, v221
    v_cvt_pk_bf16_f32 v235, v222, v223
    v_pk_max_i16 v232, v232, 0
    v_pk_max_i16 v233, v233, 0
    v_pk_max_i16 v234, v234, 0
    v_pk_max_i16 v235, v235, 0
    buffer_store_dwordx4 v[232:235], v240, s[32:35], s64 offen offset:2048 sc1
    v_pk_mul_f32 v[228:229], v[48:49], v[22:23] op_sel:[0,1] op_sel_hi:[1,1]
    v_pk_fma_f32 v[208:209], v[208:209], v[22:23], v[228:229] op_sel:[0,0,0] op_sel_hi:[1,0,1]
    v_pk_mul_f32 v[228:229], v[50:51], v[22:23] op_sel:[0,1] op_sel_hi:[1,1]
    v_pk_fma_f32 v[210:211], v[210:211], v[22:23], v[228:229] op_sel:[0,0,0] op_sel_hi:[1,0,1]
    v_cvt_pk_bf16_f32 v236, v208, v209
    v_cvt_pk_bf16_f32 v237, v210, v211
    v_pk_mul_f32 v[228:229], v[52:53], v[22:23] op_sel:[0,1] op_sel_hi:[1,1]
    v_pk_fma_f32 v[224:225], v[224:225], v[22:23], v[228:229] op_sel:[0,0,0] op_sel_hi:[1,0,1]
    v_pk_mul_f32 v[228:229], v[54:55], v[22:23] op_sel:[0,1] op_sel_hi:[1,1]
    v_pk_fma_f32 v[226:227], v[226:227], v[22:23], v[228:229] op_sel:[0,0,0] op_sel_hi:[1,0,1]
    v_cvt_pk_bf16_f32 v238, v224, v225
    v_cvt_pk_bf16_f32 v239, v226, v227
    v_pk_max_i16 v236, v236, 0
    v_pk_max_i16 v237, v237, 0
    v_pk_max_i16 v238, v238, 0
    v_pk_max_i16 v239, v239, 0
    buffer_store_dwordx4 v[236:239], v240, s[32:35], s64 offen offset:3072 sc1
    s_branch K1_PD_9
K1_PQ_8:
    s_lshl_b32 s63, s70, 1
    s_lshl_b32 s64, s45, 1
    s_add_u32 s64, s64, s48
    s_mul_i32 s64, s64, 20
    s_add_u32 s63, s63, s64
    s_lshl_b32 s63, s63, 12
    s_add_u32 s63, s63, 7077888
    s_add_u32 s64, s63, 4096
    v_pk_mul_f32 v[228:229], v[40:41], v[16:17] op_sel:[0,1] op_sel_hi:[1,1]
    v_pk_fma_f32 v[164:165], v[164:165], v[16:17], v[228:229] op_sel:[0,0,0] op_sel_hi:[1,0,1]
    v_pk_mul_f32 v[228:229], v[42:43], v[16:17] op_sel:[0,1] op_sel_hi:[1,1]
    v_pk_fma_f32 v[166:167], v[166:167], v[16:17], v[228:229] op_sel:[0,0,0] op_sel_hi:[1,0,1]
    v_cvt_pk_bf16_f32 v232, v164, v165
    v_cvt_pk_bf16_f32 v233, v166, v167
    v_pk_mul_f32 v[228:229], v[44:45], v[16:17] op_sel:[0,1] op_sel_hi:[1,1]
    v_pk_fma_f32 v[180:181], v[180:181], v[16:17], v[228:229] op_sel:[0,0,0] op_sel_hi:[1,0,1]
    v_pk_mul_f32 v[228:229], v[46:47], v[16:17] op_sel:[0,1] op_sel_hi:[1,1]
    v_pk_fma_f32 v[182:183], v[182:183], v[16:17], v[228:229] op_sel:[0,0,0] op_sel_hi:[1,0,1]
    v_cvt_pk_bf16_f32 v234, v180, v181
    v_cvt_pk_bf16_f32 v235, v182, v183
    buffer_store_dwordx4 v[232:235], v240, s[32:35], s63 offen offset:0 sc1
    v_pk_mul_f32 v[228:229], v[40:41], v[18:19] op_sel:[0,1] op_sel_hi:[1,1]
    v_pk_fma_f32 v[168:169], v[168:169], v[18:19], v[228:229] op_sel:[0,0,0] op_sel_hi:[1,0,1]
    v_pk_mul_f32 v[228:229], v[42:43], v[18:19] op_sel:[0,1] op_sel_hi:[1,1]
    v_pk_fma_f32 v[170:171], v[170:171], v[18:19], v[228:229] op_sel:[0,0,0] op_sel_hi:[1,0,1]
    v_cvt_pk_bf16_f32 v236, v168, v169
    v_cvt_pk_bf16_f32 v237, v170, v171
    v_pk_mul_f32 v[228:229], v[44:45], v[18:19] op_sel:[0,1] op_sel_hi:[1,1]
    v_pk_fma_f32 v[184:185], v[184:185], v[18:19], v[228:229] op_sel:[0,0,0] op_sel_hi:[1,0,1]
    v_pk_mul_f32 v[228:229], v[46:47], v[18:19] op_sel:[0,1] op_sel_hi:[1,1]
    v_pk_fma_f32 v[186:187], v[186:187], v[18:19], v[228:229] op_sel:[0,0,0] op_sel_hi:[1,0,1]
    v_cvt_pk_bf16_f32 v238, v184, v185
    v_cvt_pk_bf16_f32 v239, v186, v187
    buffer_store_dwordx4 v[236:239], v240, s[32:35], s63 offen offset:1024 sc1
    v_pk_mul_f32 v[228:229], v[40:41], v[20:21] op_sel:[0,1] op_sel_hi:[1,1]
    v_pk_fma_f32 v[172:173], v[172:173], v[20:21], v[228:229] op_sel:[0,0,0] op_sel_hi:[1,0,1]
    v_pk_mul_f32 v[228:229], v[42:43], v[20:21] op_sel:[0,1] op_sel_hi:[1,1]
    v_pk_fma_f32 v[174:175], v[174:175], v[20:21], v[228:229] op_sel:[0,0,0] op_sel_hi:[1,0,1]
    v_cvt_pk_bf16_f32 v232, v172, v173
    v_cvt_pk_bf16_f32 v233, v174, v175
    v_pk_mul_f32 v[228:229], v[44:45], v[20:21] op_sel:[0,1] op_sel_hi:[1,1]
    v_pk_fma_f32 v[188:189], v[188:189], v[20:21], v[228:229] op_sel:[0,0,0] op_sel_hi:[1,0,1]
    v_pk_mul_f32 v[228:229], v[46:47], v[20:21] op_sel:[0,1] op_sel_hi:[1,1]
    v_pk_fma_f32 v[190:191], v[190:191], v[20:21], v[228:229] op_sel:[0,0,0] op_sel_hi:[1,0,1]
    v_cvt_pk_bf16_f32 v234, v188, v189
    v_cvt_pk_bf16_f32 v235, v190, v191
    buffer_store_dwordx4 v[232:235], v240, s[32:35], s63 offen offset:2048 sc1
    v_pk_mul_f32 v[228:229], v[40:41], v[22:23] op_sel:[0,1] op_sel_hi:[1,1]
    v_pk_fma_f32 v[176:177], v[176:177], v[22:23], v[228:229] op_sel:[0,0,0] op_sel_hi:[1,0,1]
    v_pk_mul_f32 v[228:229], v[42:43], v[22:23] op_sel:[0,1] op_sel_hi:[1,1]
    v_pk_fma_f32 v[178:179], v[178:179], v[22:23], v[228:229] op_sel:[0,0,0] op_sel_hi:[1,0,1]
    v_cvt_pk_bf16_f32 v236, v176, v177
    v_cvt_pk_bf16_f32 v237, v178, v179
    v_pk_mul_f32 v[228:229], v[44:45], v[22:23] op_sel:[0,1] op_sel_hi:[1,1]
    v_pk_fma_f32 v[192:193], v[192:193], v[22:23], v[228:229] op_sel:[0,0,0] op_sel_hi:[1,0,1]
    v_pk_mul_f32 v[228:229], v[46:47], v[22:23] op_sel:[0,1] op_sel_hi:[1,1]
    v_pk_fma_f32 v[194:195], v[194:195], v[22:23], v[228:229] op_sel:[0,0,0] op_sel_hi:[1,0,1]
    v_cvt_pk_bf16_f32 v238, v192, v193
    v_cvt_pk_bf16_f32 v239, v194, v195
    buffer_store_dwordx4 v[236:239], v240, s[32:35], s63 offen offset:3072 sc1
    v_pk_mul_f32 v[228:229], v[48:49], v[16:17] op_sel:[0,1] op_sel_hi:[1,1]
    v_pk_fma_f32 v[196:197], v[196:197], v[16:17], v[228:229] op_sel:[0,0,0] op_sel_hi:[1,0,1]
    v_pk_mul_f32 v[228:229], v[50:51], v[16:17] op_sel:[0,1] op_sel_hi:[1,1]
    v_pk_fma_f32 v[198:199], v[198:199], v[16:17], v[228:229] op_sel:[0,0,0] op_sel_hi:[1,0,1]
    v_cvt_pk_bf16_f32 v232, v196, v197
    v_cvt_pk_bf16_f32 v233, v198, v199
    v_pk_mul_f32 v[228:229], v[52:53], v[16:17] op_sel:[0,1] op_sel_hi:[1,1]
    v_pk_fma_f32 v[212:213], v[212:213], v[16:17], v[228:229] op_sel:[0,0,0] op_sel_hi:[1,0,1]
    v_pk_mul_f32 v[228:229], v[54:55], v[16:17] op_sel:[0,1] op_sel_hi:[1,1]
    v_pk_fma_f32 v[214:215], v[214:215], v[16:17], v[228:229] op_sel:[0,0,0] op_sel_hi:[1,0,1]
    v_cvt_pk_bf16_f32 v234, v212, v213
    v_cvt_pk_bf16_f32 v235, v214, v215
    buffer_store_dwordx4 v[232:235], v240, s[32:35], s64 offen offset:0 sc1
    v_pk_mul_f32 v[228:229], v[48:49], v[18:19] op_sel:[0,1] op_sel_hi:[1,1]
    v_pk_fma_f32 v[200:201], v[200:201], v[18:19], v[228:229] op_sel:[0,0,0] op_sel_hi:[1,0,1]
    v_pk_mul_f32 v[228:229], v[50:51], v[18:19] op_sel:[0,1] op_sel_hi:[1,1]
    v_pk_fma_f32 v[202:203], v[202:203], v[18:19], v[228:229] op_sel:[0,0,0] op_sel_hi:[1,0,1]
    v_cvt_pk_bf16_f32 v236, v200, v201
    v_cvt_pk_bf16_f32 v237, v202, v203
    v_pk_mul_f32 v[228:229], v[52:53], v[18:19] op_sel:[0,1] op_sel_hi:[1,1]
    v_pk_fma_f32 v[216:217], v[216:217], v[18:19], v[228:229] op_sel:[0,0,0] op_sel_hi:[1,0,1]
    v_pk_mul_f32 v[228:229], v[54:55], v[18:19] op_sel:[0,1] op_sel_hi:[1,1]
    v_pk_fma_f32 v[218:219], v[218:219], v[18:19], v[228:229] op_sel:[0,0,0] op_sel_hi:[1,0,1]
    v_cvt_pk_bf16_f32 v238, v216, v217
    v_cvt_pk_bf16_f32 v239, v218, v219
    buffer_store_dwordx4 v[236:239], v240, s[32:35], s64 offen offset:1024 sc1
    v_pk_mul_f32 v[228:229], v[48:49], v[20:21] op_sel:[0,1] op_sel_hi:[1,1]
    v_pk_fma_f32 v[204:205], v[204:205], v[20:21], v[228:229] op_sel:[0,0,0] op_sel_hi:[1,0,1]
    v_pk_mul_f32 v[228:229], v[50:51], v[20:21] op_sel:[0,1] op_sel_hi:[1,1]
    v_pk_fma_f32 v[206:207], v[206:207], v[20:21], v[228:229] op_sel:[0,0,0] op_sel_hi:[1,0,1]
    v_cvt_pk_bf16_f32 v232, v204, v205
    v_cvt_pk_bf16_f32 v233, v206, v207
    v_pk_mul_f32 v[228:229], v[52:53], v[20:21] op_sel:[0,1] op_sel_hi:[1,1]
    v_pk_fma_f32 v[220:221], v[220:221], v[20:21], v[228:229] op_sel:[0,0,0] op_sel_hi:[1,0,1]
    v_pk_mul_f32 v[228:229], v[54:55], v[20:21] op_sel:[0,1] op_sel_hi:[1,1]
    v_pk_fma_f32 v[222:223], v[222:223], v[20:21], v[228:229] op_sel:[0,0,0] op_sel_hi:[1,0,1]
    v_cvt_pk_bf16_f32 v234, v220, v221
    v_cvt_pk_bf16_f32 v235, v222, v223
    buffer_store_dwordx4 v[232:235], v240, s[32:35], s64 offen offset:2048 sc1
    v_pk_mul_f32 v[228:229], v[48:49], v[22:23] op_sel:[0,1] op_sel_hi:[1,1]
    v_pk_fma_f32 v[208:209], v[208:209], v[22:23], v[228:229] op_sel:[0,0,0] op_sel_hi:[1,0,1]
    v_pk_mul_f32 v[228:229], v[50:51], v[22:23] op_sel:[0,1] op_sel_hi:[1,1]
    v_pk_fma_f32 v[210:211], v[210:211], v[22:23], v[228:229] op_sel:[0,0,0] op_sel_hi:[1,0,1]
    v_cvt_pk_bf16_f32 v236, v208, v209
    v_cvt_pk_bf16_f32 v237, v210, v211
    v_pk_mul_f32 v[228:229], v[52:53], v[22:23] op_sel:[0,1] op_sel_hi:[1,1]
    v_pk_fma_f32 v[224:225], v[224:225], v[22:23], v[228:229] op_sel:[0,0,0] op_sel_hi:[1,0,1]
    v_pk_mul_f32 v[228:229], v[54:55], v[22:23] op_sel:[0,1] op_sel_hi:[1,1]
    v_pk_fma_f32 v[226:227], v[226:227], v[22:23], v[228:229] op_sel:[0,0,0] op_sel_hi:[1,0,1]
    v_cvt_pk_bf16_f32 v238, v224, v225
    v_cvt_pk_bf16_f32 v239, v226, v227
    buffer_store_dwordx4 v[236:239], v240, s[32:35], s64 offen offset:3072 sc1
K1_PD_9:
K1_END:
    s_waitcnt vmcnt(0)
K1_EXIT:
    s_endpgm
.globl hh2_kernel
.p2align 8
.type hh2_kernel,@function
hh2_kernel:
    s_cmp_ge_u32 s2, 256
    s_cbranch_scc1 K2_EXIT
    s_load_dwordx2 s[8:9], s[0:1], 0
    s_load_dwordx2 s[12:13], s[0:1], 16
    s_load_dwordx4 s[16:19], s[0:1], 56
    s_load_dwordx2 s[20:21], s[0:1], 72
    v_and_b32 v1, 63, v0
    v_lshrrev_b32 v6, 6, v0
    v_lshrrev_b32 v2, 4, v1
    v_readfirstlane_b32 s44, v6
    s_nop 3
    v_and_b32 v3, 15, v1
    v_lshlrev_b32 v4, 4, v1
    v_add_u32 v5, 4096, v4
    v_lshlrev_b32 v18, 3, v1
    s_and_b32 s50, s2, 7
    s_lshr_b32 s51, s2, 3
    s_lshr_b32 s52, s50, 1
    s_lshl_b32 s45, s52, 3
    s_and_b32 s52, s51, 7
    s_add_u32 s45, s45, s52
    s_and_b32 s52, s50, 1
    s_lshl_b32 s46, s52, 2
    s_lshr_b32 s52, s51, 3
    s_add_u32 s46, s46, s52
    s_lshl_b32 s47, s50, 2
    s_and_b32 s52, s51, 3
    s_add_u32 s47, s47, s52
    s_lshr_b32 s48, s51, 2
    s_sub_u32 s49, s44, 4
    s_waitcnt lgkmcnt(0)
    s_mov_b32 s24, s20
    s_mov_b32 s25, s21
    s_mov_b32 s26, 16312320
    s_mov_b32 s27, 0x20000
    s_cmp_lt_u32 s44, 4
    s_cbranch_scc0 K2_PROD
    s_mul_i32 s50, s44, 14
    s_cmp_eq_u32 s44, 3
    s_cselect_b32 s50, 41, s50
    s_mul_i32 s51, s45, 54
    s_add_u32 s51, s51, s50
    s_lshl_b32 s54, s51, 12
    s_mul_i32 s51, s46, 74
    s_add_u32 s52, s51, s50
    s_mul_i32 s55, s52, 5120
    s_add_u32 s55, s55, 10616832
    s_sub_u32 s50, s46, s45
    s_and_b32 s50, s50, 3
    s_sub_u32 s51, 0, s50
    s_and_b32 s51, s51, 3
    s_mov_b32 s66, 2
    s_cmp_eq_u32 s51, 1
    s_cselect_b32 s66, 4294967295, s66
    s_cmp_eq_u32 s51, 2
    s_cselect_b32 s66, 4294967295, s66
    s_cmp_eq_u32 s51, 3
    s_cselect_b32 s66, 0, s66
    s_sub_u32 s51, 1, s50
    s_and_b32 s51, s51, 3
    s_mov_b32 s67, 2
    s_cmp_eq_u32 s51, 1
    s_cselect_b32 s67, 4294967295, s67
    s_cmp_eq_u32 s51, 2
    s_cselect_b32 s67, 4294967295, s67
    s_cmp_eq_u32 s51, 3
    s_cselect_b32 s67, 0, s67
    s_sub_u32 s51, 2, s50
    s_and_b32 s51, s51, 3
    s_mov_b32 s68, 2
    s_cmp_eq_u32 s51, 1
    s_cselect_b32 s68, 4294967295, s68
    s_cmp_eq_u32 s51, 2
    s_cselect_b32 s68, 4294967295, s68
    s_cmp_eq_u32 s51, 3
    s_cselect_b32 s68, 0, s68
    s_sub_u32 s51, 3, s50
    s_and_b32 s51, s51, 3
    s_mov_b32 s69, 2
    s_cmp_eq_u32 s51, 1
    s_cselect_b32 s69, 4294967295, s69
    s_cmp_eq_u32 s51, 2
    s_cselect_b32 s69, 4294967295, s69
    s_cmp_eq_u32 s51, 3
    s_cselect_b32 s69, 0, s69
    s_barrier
    s_nop 0
    s_add_u32 s70, s66, 0
    s_cmp_lt_i32 s70, 0
    s_cselect_b32 s71, 12, 0
    s_add_u32 s70, s70, s71
    s_cmp_ge_i32 s70, 12
    s_cselect_b32 s71, 12, 0
    s_sub_u32 s70, s70, s71
    s_lshl_b32 s71, s70, 12
    s_add_u32 s59, s54, s71
    s_mul_i32 s71, s70, 5120
    s_add_u32 s60, s55, s71
    buffer_load_dwordx4 v[40:43], v4, s[24:27], s59 offen offset:0
    buffer_load_dwordx4 v[44:47], v4, s[24:27], s59 offen offset:1024
    buffer_load_dwordx4 v[48:51], v4, s[24:27], s59 offen offset:2048
    buffer_load_dwordx4 v[52:55], v4, s[24:27], s59 offen offset:3072
    buffer_load_dwordx4 v[20:23], v4, s[24:27], s60 offen offset:0
    buffer_load_dwordx4 v[24:27], v4, s[24:27], s60 offen offset:1024
    buffer_load_dwordx4 v[28:31], v4, s[24:27], s60 offen offset:2048
    buffer_load_dwordx4 v[32:35], v4, s[24:27], s60 offen offset:3072
    buffer_load_dwordx4 v[36:39], v5, s[24:27], s60 offen offset:0
    s_nop 0
    s_add_u32 s70, s67, 1
    s_cmp_lt_i32 s70, 0
    s_cselect_b32 s71, 12, 0
    s_add_u32 s70, s70, s71
    s_cmp_ge_i32 s70, 12
    s_cselect_b32 s71, 12, 0
    s_sub_u32 s70, s70, s71
    s_lshl_b32 s71, s70, 12
    s_add_u32 s59, s54, s71
    s_mul_i32 s71, s70, 5120
    s_add_u32 s60, s55, s71
    buffer_load_dwordx4 v[76:79], v4, s[24:27], s59 offen offset:0
    buffer_load_dwordx4 v[80:83], v4, s[24:27], s59 offen offset:1024
    buffer_load_dwordx4 v[84:87], v4, s[24:27], s59 offen offset:2048
    buffer_load_dwordx4 v[88:91], v4, s[24:27], s59 offen offset:3072
    buffer_load_dwordx4 v[56:59], v4, s[24:27], s60 offen offset:0
    buffer_load_dwordx4 v[60:63], v4, s[24:27], s60 offen offset:1024
    buffer_load_dwordx4 v[64:67], v4, s[24:27], s60 offen offset:2048
    buffer_load_dwordx4 v[68:71], v4, s[24:27], s60 offen offset:3072
    buffer_load_dwordx4 v[72:75], v5, s[24:27], s60 offen offset:0
    s_nop 0
    s_add_u32 s70, s68, 2
    s_cmp_lt_i32 s70, 0
    s_cselect_b32 s71, 12, 0
    s_add_u32 s70, s70, s71
    s_cmp_ge_i32 s70, 12
    s_cselect_b32 s71, 12, 0
    s_sub_u32 s70, s70, s71
    s_lshl_b32 s71, s70, 12
    s_add_u32 s59, s54, s71
    s_mul_i32 s71, s70, 5120
    s_add_u32 s60, s55, s71
    buffer_load_dwordx4 v[112:115], v4, s[24:27], s59 offen offset:0
    buffer_load_dwordx4 v[116:119], v4, s[24:27], s59 offen offset:1024
    buffer_load_dwordx4 v[120:123], v4, s[24:27], s59 offen offset:2048
    buffer_load_dwordx4 v[124:127], v4, s[24:27], s59 offen offset:3072
    buffer_load_dwordx4 v[92:95], v4, s[24:27], s60 offen offset:0
    buffer_load_dwordx4 v[96:99], v4, s[24:27], s60 offen offset:1024
    buffer_load_dwordx4 v[100:103], v4, s[24:27], s60 offen offset:2048
    buffer_load_dwordx4 v[104:107], v4, s[24:27], s60 offen offset:3072
    buffer_load_dwordx4 v[108:111], v5, s[24:27], s60 offen offset:0
    s_nop 0
    s_add_u32 s70, s69, 3
    s_cmp_lt_i32 s70, 0
    s_cselect_b32 s71, 12, 0
    s_add_u32 s70, s70, s71
    s_cmp_ge_i32 s70, 12
    s_cselect_b32 s71, 12, 0
    s_sub_u32 s70, s70, s71
    s_lshl_b32 s71, s70, 12
    s_add_u32 s59, s54, s71
    s_mul_i32 s71, s70, 5120
    s_add_u32 s60, s55, s71
    buffer_load_dwordx4 a[100:103], v4, s[24:27], s59 offen offset:0
    buffer_load_dwordx4 a[104:107], v4, s[24:27], s59 offen offset:1024
    buffer_load_dwordx4 a[108:111], v4, s[24:27], s59 offen offset:2048
    buffer_load_dwordx4 a[112:115], v4, s[24:27], s59 offen offset:3072
    buffer_load_dwordx4 a[80:83], v4, s[24:27], s60 offen offset:0
    buffer_load_dwordx4 a[84:87], v4, s[24:27], s60 offen offset:1024
    buffer_load_dwordx4 a[88:91], v4, s[24:27], s60 offen offset:2048
    buffer_load_dwordx4 a[92:95], v4, s[24:27], s60 offen offset:3072
    buffer_load_dwordx4 a[96:99], v5, s[24:27], s60 offen offset:0
    v_accvgpr_write_b32 a0, 0
    v_accvgpr_write_b32 a1, 0
    v_accvgpr_write_b32 a2, 0
    v_accvgpr_write_b32 a3, 0
    v_accvgpr_write_b32 a4, 0
    v_accvgpr_write_b32 a5, 0
    v_accvgpr_write_b32 a6, 0
    v_accvgpr_write_b32 a7, 0
    v_accvgpr_write_b32 a8, 0
    v_accvgpr_write_b32 a9, 0
    v_accvgpr_write_b32 a10, 0
    v_accvgpr_write_b32 a11, 0
    v_accvgpr_write_b32 a12, 0
    v_accvgpr_write_b32 a13, 0
    v_accvgpr_write_b32 a14, 0
    v_accvgpr_write_b32 a15, 0
    v_accvgpr_write_b32 a16, 0
    v_accvgpr_write_b32 a17, 0
    v_accvgpr_write_b32 a18, 0
    v_accvgpr_write_b32 a19, 0
    v_accvgpr_write_b32 a20, 0
    v_accvgpr_write_b32 a21, 0
    v_accvgpr_write_b32 a22, 0
    v_accvgpr_write_b32 a23, 0
    v_accvgpr_write_b32 a24, 0
    v_accvgpr_write_b32 a25, 0
    v_accvgpr_write_b32 a26, 0
    v_accvgpr_write_b32 a27, 0
    v_accvgpr_write_b32 a28, 0
    v_accvgpr_write_b32 a29, 0
    v_accvgpr_write_b32 a30, 0
    v_accvgpr_write_b32 a31, 0
    v_accvgpr_write_b32 a32, 0
    v_accvgpr_write_b32 a33, 0
    v_accvgpr_write_b32 a34, 0
    v_accvgpr_write_b32 a35, 0
    v_accvgpr_write_b32 a36, 0
    v_accvgpr_write_b32 a37, 0
    v_accvgpr_write_b32 a38, 0
    v_accvgpr_write_b32 a39, 0
    v_accvgpr_write_b32 a40, 0
    v_accvgpr_write_b32 a41, 0
    v_accvgpr_write_b32 a42, 0
    v_accvgpr_write_b32 a43, 0
    v_accvgpr_write_b32 a44, 0
    v_accvgpr_write_b32 a45, 0
    v_accvgpr_write_b32 a46, 0
    v_accvgpr_write_b32 a47, 0
    v_accvgpr_write_b32 a48, 0
    v_accvgpr_write_b32 a49, 0
    v_accvgpr_write_b32 a50, 0
    v_accvgpr_write_b32 a51, 0
    v_accvgpr_write_b32 a52, 0
    v_accvgpr_write_b32 a53, 0
    v_accvgpr_write_b32 a54, 0
    v_accvgpr_write_b32 a55, 0
    v_accvgpr_write_b32 a56, 0
    v_accvgpr_write_b32 a57, 0
    v_accvgpr_write_b32 a58, 0
    v_accvgpr_write_b32 a59, 0
    v_accvgpr_write_b32 a60, 0
    v_accvgpr_write_b32 a61, 0
    v_accvgpr_write_b32 a62, 0
    v_accvgpr_write_b32 a63, 0
    v_accvgpr_write_b32 a64, 0
    v_accvgpr_write_b32 a65, 0
    v_accvgpr_write_b32 a66, 0
    v_accvgpr_write_b32 a67, 0
    v_accvgpr_write_b32 a68, 0
    v_accvgpr_write_b32 a69, 0
    v_accvgpr_write_b32 a70, 0
    v_accvgpr_write_b32 a71, 0
    v_accvgpr_write_b32 a72, 0
    v_accvgpr_write_b32 a73, 0
    v_accvgpr_write_b32 a74, 0
    v_accvgpr_write_b32 a75, 0
    v_accvgpr_write_b32 a76, 0
    v_accvgpr_write_b32 a77, 0
    v_accvgpr_write_b32 a78, 0
    v_accvgpr_write_b32 a79, 0
    s_mul_i32 s50, s44, 5
    s_mul_i32 s51, s46, 74
    s_add_u32 s52, s51, s50
    s_add_u32 s52, s52, 54
    s_mul_i32 s57, s52, 5120
    s_add_u32 s57, s57, 10616832
    s_mul_i32 s51, s45, 20
    s_add_u32 s51, s51, s50
    s_lshl_b32 s56, s51, 12
    s_add_u32 s56, s56, 13647872
    s_add_u32 s58, s54, 53248
    s_cmp_ge_u32 s44, 2
    s_cselect_b32 s58, 2147475440, s58
    s_mov_b32 s28, s8
    s_mov_b32 s29, s9
    s_mov_b32 s30, 2621440
    s_mov_b32 s31, 0x20000
    s_mov_b32 s32, s16
    s_mov_b32 s33, s17
    s_mov_b32 s34, 2621440
    s_mov_b32 s35, 0x20000
    s_lshr_b32 s50, s45, 2
    s_lshl_b32 s50, s50, 7
    s_add_u32 s63, s50, 16269312
    v_and_b32 v8, 31, v1
    v_lshlrev_b32 v8, 2, v8
    s_waitcnt vmcnt(27)
    s_nop 0
    s_add_u32 s70, s66, 4
    s_cmp_lt_i32 s70, 0
    s_cselect_b32 s71, 12, 0
    s_add_u32 s70, s70, s71
    s_cmp_ge_i32 s70, 12
    s_cselect_b32 s71, 12, 0
    s_sub_u32 s70, s70, s71
    s_lshl_b32 s71, s70, 12
    s_add_u32 s59, s54, s71
    s_mul_i32 s71, s70, 5120
    s_add_u32 s60, s55, s71
    v_mfma_f32_16x16x32_bf16 a[0:3], v[20:23], v[40:43], a[0:3]
    v_mfma_f32_16x16x32_bf16 a[4:7], v[20:23], v[44:47], a[4:7]
    v_mfma_f32_16x16x32_bf16 a[8:11], v[20:23], v[48:51], a[8:11]
    v_mfma_f32_16x16x32_bf16 a[12:15], v[20:23], v[52:55], a[12:15]
    buffer_load_dwordx4 v[20:23], v4, s[24:27], s60 offen offset:0
    v_mfma_f32_16x16x32_bf16 a[16:19], v[24:27], v[40:43], a[16:19]
    v_mfma_f32_16x16x32_bf16 a[20:23], v[24:27], v[44:47], a[20:23]
    v_mfma_f32_16x16x32_bf16 a[24:27], v[24:27], v[48:51], a[24:27]
    v_mfma_f32_16x16x32_bf16 a[28:31], v[24:27], v[52:55], a[28:31]
    buffer_load_dwordx4 v[24:27], v4, s[24:27], s60 offen offset:1024
    v_mfma_f32_16x16x32_bf16 a[32:35], v[28:31], v[40:43], a[32:35]
    v_mfma_f32_16x16x32_bf16 a[36:39], v[28:31], v[44:47], a[36:39]
    v_mfma_f32_16x16x32_bf16 a[40:43], v[28:31], v[48:51], a[40:43]
    v_mfma_f32_16x16x32_bf16 a[44:47], v[28:31], v[52:55], a[44:47]
    buffer_load_dwordx4 v[28:31], v4, s[24:27], s60 offen offset:2048
    v_mfma_f32_16x16x32_bf16 a[48:51], v[32:35], v[40:43], a[48:51]
    v_mfma_f32_16x16x32_bf16 a[52:55], v[32:35], v[44:47], a[52:55]
    v_mfma_f32_16x16x32_bf16 a[56:59], v[32:35], v[48:51], a[56:59]
    v_mfma_f32_16x16x32_bf16 a[60:63], v[32:35], v[52:55], a[60:63]
    buffer_load_dwordx4 v[32:35], v4, s[24:27], s60 offen offset:3072
    v_mfma_f32_16x16x32_bf16 a[64:67], v[36:39], v[40:43], a[64:67]
    v_mfma_f32_16x16x32_bf16 a[68:71], v[36:39], v[44:47], a[68:71]
    v_mfma_f32_16x16x32_bf16 a[72:75], v[36:39], v[48:51], a[72:75]
    v_mfma_f32_16x16x32_bf16 a[76:79], v[36:39], v[52:55], a[76:79]
    buffer_load_dwordx4 v[36:39], v5, s[24:27], s60 offen offset:0
    buffer_load_dwordx4 v[40:43], v4, s[24:27], s59 offen offset:0
    buffer_load_dwordx4 v[44:47], v4, s[24:27], s59 offen offset:1024
    buffer_load_dwordx4 v[48:51], v4, s[24:27], s59 offen offset:2048
    buffer_load_dwordx4 v[52:55], v4, s[24:27], s59 offen offset:3072
    s_waitcnt vmcnt(27)
    s_nop 0
    s_add_u32 s70, s67, 5
    s_cmp_lt_i32 s70, 0
    s_cselect_b32 s71, 12, 0
    s_add_u32 s70, s70, s71
    s_cmp_ge_i32 s70, 12
    s_cselect_b32 s71, 12, 0
    s_sub_u32 s70, s70, s71
    s_lshl_b32 s71, s70, 12
    s_add_u32 s59, s54, s71
    s_mul_i32 s71, s70, 5120
    s_add_u32 s60, s55, s71
    v_mfma_f32_16x16x32_bf16 a[0:3], v[56:59], v[76:79], a[0:3]
    v_mfma_f32_16x16x32_bf16 a[4:7], v[56:59], v[80:83], a[4:7]
    v_mfma_f32_16x16x32_bf16 a[8:11], v[56:59], v[84:87], a[8:11]
    v_mfma_f32_16x16x32_bf16 a[12:15], v[56:59], v[88:91], a[12:15]
    buffer_load_dwordx4 v[56:59], v4, s[24:27], s60 offen offset:0
    v_mfma_f32_16x16x32_bf16 a[16:19], v[60:63], v[76:79], a[16:19]
    v_mfma_f32_16x16x32_bf16 a[20:23], v[60:63], v[80:83], a[20:23]
    v_mfma_f32_16x16x32_bf16 a[24:27], v[60:63], v[84:87], a[24:27]
    v_mfma_f32_16x16x32_bf16 a[28:31], v[60:63], v[88:91], a[28:31]
    buffer_load_dwordx4 v[60:63], v4, s[24:27], s60 offen offset:1024
    v_mfma_f32_16x16x32_bf16 a[32:35], v[64:67], v[76:79], a[32:35]
    v_mfma_f32_16x16x32_bf16 a[36:39], v[64:67], v[80:83], a[36:39]
    v_mfma_f32_16x16x32_bf16 a[40:43], v[64:67], v[84:87], a[40:43]
    v_mfma_f32_16x16x32_bf16 a[44:47], v[64:67], v[88:91], a[44:47]
    buffer_load_dwordx4 v[64:67], v4, s[24:27], s60 offen offset:2048
    v_mfma_f32_16x16x32_bf16 a[48:51], v[68:71], v[76:79], a[48:51]
    v_mfma_f32_16x16x32_bf16 a[52:55], v[68:71], v[80:83], a[52:55]
    v_mfma_f32_16x16x32_bf16 a[56:59], v[68:71], v[84:87], a[56:59]
    v_mfma_f32_16x16x32_bf16 a[60:63], v[68:71], v[88:91], a[60:63]
    buffer_load_dwordx4 v[68:71], v4, s[24:27], s60 offen offset:3072
    v_mfma_f32_16x16x32_bf16 a[64:67], v[72:75], v[76:79], a[64:67]
    v_mfma_f32_16x16x32_bf16 a[68:71], v[72:75], v[80:83], a[68:71]
    v_mfma_f32_16x16x32_bf16 a[72:75], v[72:75], v[84:87], a[72:75]
    v_mfma_f32_16x16x32_bf16 a[76:79], v[72:75], v[88:91], a[76:79]
    buffer_load_dwordx4 v[72:75], v5, s[24:27], s60 offen offset:0
    buffer_load_dwordx4 v[76:79], v4, s[24:27], s59 offen offset:0
    buffer_load_dwordx4 v[80:83], v4, s[24:27], s59 offen offset:1024
    buffer_load_dwordx4 v[84:87], v4, s[24:27], s59 offen offset:2048
    buffer_load_dwordx4 v[88:91], v4, s[24:27], s59 offen offset:3072
    s_waitcnt vmcnt(27)
    s_nop 0
    s_add_u32 s70, s68, 6
    s_cmp_lt_i32 s70, 0
    s_cselect_b32 s71, 12, 0
    s_add_u32 s70, s70, s71
    s_cmp_ge_i32 s70, 12
    s_cselect_b32 s71, 12, 0
    s_sub_u32 s70, s70, s71
    s_lshl_b32 s71, s70, 12
    s_add_u32 s59, s54, s71
    s_mul_i32 s71, s70, 5120
    s_add_u32 s60, s55, s71
    v_mfma_f32_16x16x32_bf16 a[0:3], v[92:95], v[112:115], a[0:3]
    v_mfma_f32_16x16x32_bf16 a[4:7], v[92:95], v[116:119], a[4:7]
    v_mfma_f32_16x16x32_bf16 a[8:11], v[92:95], v[120:123], a[8:11]
    v_mfma_f32_16x16x32_bf16 a[12:15], v[92:95], v[124:127], a[12:15]
    buffer_load_dwordx4 v[92:95], v4, s[24:27], s60 offen offset:0
    v_mfma_f32_16x16x32_bf16 a[16:19], v[96:99], v[112:115], a[16:19]
    v_mfma_f32_16x16x32_bf16 a[20:23], v[96:99], v[116:119], a[20:23]
    v_mfma_f32_16x16x32_bf16 a[24:27], v[96:99], v[120:123], a[24:27]
    v_mfma_f32_16x16x32_bf16 a[28:31], v[96:99], v[124:127], a[28:31]
    buffer_load_dwordx4 v[96:99], v4, s[24:27], s60 offen offset:1024
    v_mfma_f32_16x16x32_bf16 a[32:35], v[100:103], v[112:115], a[32:35]
    v_mfma_f32_16x16x32_bf16 a[36:39], v[100:103], v[116:119], a[36:39]
    v_mfma_f32_16x16x32_bf16 a[40:43], v[100:103], v[120:123], a[40:43]
    v_mfma_f32_16x16x32_bf16 a[44:47], v[100:103], v[124:127], a[44:47]
    buffer_load_dwordx4 v[100:103], v4, s[24:27], s60 offen offset:2048
    v_mfma_f32_16x16x32_bf16 a[48:51], v[104:107], v[112:115], a[48:51]
    v_mfma_f32_16x16x32_bf16 a[52:55], v[104:107], v[116:119], a[52:55]
    v_mfma_f32_16x16x32_bf16 a[56:59], v[104:107], v[120:123], a[56:59]
    v_mfma_f32_16x16x32_bf16 a[60:63], v[104:107], v[124:127], a[60:63]
    buffer_load_dwordx4 v[104:107], v4, s[24:27], s60 offen offset:3072
    v_mfma_f32_16x16x32_bf16 a[64:67], v[108:111], v[112:115], a[64:67]
    v_mfma_f32_16x16x32_bf16 a[68:71], v[108:111], v[116:119], a[68:71]
    v_mfma_f32_16x16x32_bf16 a[72:75], v[108:111], v[120:123], a[72:75]
    v_mfma_f32_16x16x32_bf16 a[76:79], v[108:111], v[124:127], a[76:79]
    buffer_load_dwordx4 v[108:111], v5, s[24:27], s60 offen offset:0
    buffer_load_dwordx4 v[112:115], v4, s[24:27], s59 offen offset:0
    buffer_load_dwordx4 v[116:119], v4, s[24:27], s59 offen offset:1024
    buffer_load_dwordx4 v[120:123], v4, s[24:27], s59 offen offset:2048
    buffer_load_dwordx4 v[124:127], v4, s[24:27], s59 offen offset:3072
    s_waitcnt vmcnt(27)
    s_nop 0
    s_add_u32 s70, s69, 7
    s_cmp_lt_i32 s70, 0
    s_cselect_b32 s71, 12, 0
    s_add_u32 s70, s70, s71
    s_cmp_ge_i32 s70, 12
    s_cselect_b32 s71, 12, 0
    s_sub_u32 s70, s70, s71
    s_lshl_b32 s71, s70, 12
    s_add_u32 s59, s54, s71
    s_mul_i32 s71, s70, 5120
    s_add_u32 s60, s55, s71
    v_mfma_f32_16x16x32_bf16 a[0:3], a[80:83], a[100:103], a[0:3]
    v_mfma_f32_16x16x32_bf16 a[4:7], a[80:83], a[104:107], a[4:7]
    v_mfma_f32_16x16x32_bf16 a[8:11], a[80:83], a[108:111], a[8:11]
    v_mfma_f32_16x16x32_bf16 a[12:15], a[80:83], a[112:115], a[12:15]
    buffer_load_dwordx4 a[80:83], v4, s[24:27], s60 offen offset:0
    v_mfma_f32_16x16x32_bf16 a[16:19], a[84:87], a[100:103], a[16:19]
    v_mfma_f32_16x16x32_bf16 a[20:23], a[84:87], a[104:107], a[20:23]
    v_mfma_f32_16x16x32_bf16 a[24:27], a[84:87], a[108:111], a[24:27]
    v_mfma_f32_16x16x32_bf16 a[28:31], a[84:87], a[112:115], a[28:31]
    buffer_load_dwordx4 a[84:87], v4, s[24:27], s60 offen offset:1024
    v_mfma_f32_16x16x32_bf16 a[32:35], a[88:91], a[100:103], a[32:35]
    v_mfma_f32_16x16x32_bf16 a[36:39], a[88:91], a[104:107], a[36:39]
    v_mfma_f32_16x16x32_bf16 a[40:43], a[88:91], a[108:111], a[40:43]
    v_mfma_f32_16x16x32_bf16 a[44:47], a[88:91], a[112:115], a[44:47]
    buffer_load_dwordx4 a[88:91], v4, s[24:27], s60 offen offset:2048
    v_mfma_f32_16x16x32_bf16 a[48:51], a[92:95], a[100:103], a[48:51]
    v_mfma_f32_16x16x32_bf16 a[52:55], a[92:95], a[104:107], a[52:55]
    v_mfma_f32_16x16x32_bf16 a[56:59], a[92:95], a[108:111], a[56:59]
    v_mfma_f32_16x16x32_bf16 a[60:63], a[92:95], a[112:115], a[60:63]
    buffer_load_dwordx4 a[92:95], v4, s[24:27], s60 offen offset:3072
    v_mfma_f32_16x16x32_bf16 a[64:67], a[96:99], a[100:103], a[64:67]
    v_mfma_f32_16x16x32_bf16 a[68:71], a[96:99], a[104:107], a[68:71]
    v_mfma_f32_16x16x32_bf16 a[72:75], a[96:99], a[108:111], a[72:75]
    v_mfma_f32_16x16x32_bf16 a[76:79], a[96:99], a[112:115], a[76:79]
    buffer_load_dwordx4 a[96:99], v5, s[24:27], s60 offen offset:0
    buffer_load_dwordx4 a[100:103], v4, s[24:27], s59 offen offset:0
    buffer_load_dwordx4 a[104:107], v4, s[24:27], s59 offen offset:1024
    buffer_load_dwordx4 a[108:111], v4, s[24:27], s59 offen offset:2048
    buffer_load_dwordx4 a[112:115], v4, s[24:27], s59 offen offset:3072
    s_waitcnt vmcnt(27)
    s_nop 0
    s_add_u32 s70, s66, 8
    s_cmp_lt_i32 s70, 0
    s_cselect_b32 s71, 12, 0
    s_add_u32 s70, s70, s71
    s_cmp_ge_i32 s70, 12
    s_cselect_b32 s71, 12, 0
    s_sub_u32 s70, s70, s71
    s_lshl_b32 s71, s70, 12
    s_add_u32 s59, s54, s71
    s_mul_i32 s71, s70, 5120
    s_add_u32 s60, s55, s71
    v_mfma_f32_16x16x32_bf16 a[0:3], v[20:23], v[40:43], a[0:3]
    v_mfma_f32_16x16x32_bf16 a[4:7], v[20:23], v[44:47], a[4:7]
    v_mfma_f32_16x16x32_bf16 a[8:11], v[20:23], v[48:51], a[8:11]
    v_mfma_f32_16x16x32_bf16 a[12:15], v[20:23], v[52:55], a[12:15]
    buffer_load_dwordx4 v[20:23], v4, s[24:27], s60 offen offset:0
    v_mfma_f32_16x16x32_bf16 a[16:19], v[24:27], v[40:43], a[16:19]
    v_mfma_f32_16x16x32_bf16 a[20:23], v[24:27], v[44:47], a[20:23]
    v_mfma_f32_16x16x32_bf16 a[24:27], v[24:27], v[48:51], a[24:27]
    v_mfma_f32_16x16x32_bf16 a[28:31], v[24:27], v[52:55], a[28:31]
    buffer_load_dwordx4 v[24:27], v4, s[24:27], s60 offen offset:1024
    v_mfma_f32_16x16x32_bf16 a[32:35], v[28:31], v[40:43], a[32:35]
    v_mfma_f32_16x16x32_bf16 a[36:39], v[28:31], v[44:47], a[36:39]
    v_mfma_f32_16x16x32_bf16 a[40:43], v[28:31], v[48:51], a[40:43]
    v_mfma_f32_16x16x32_bf16 a[44:47], v[28:31], v[52:55], a[44:47]
    buffer_load_dwordx4 v[28:31], v4, s[24:27], s60 offen offset:2048
    v_mfma_f32_16x16x32_bf16 a[48:51], v[32:35], v[40:43], a[48:51]
    v_mfma_f32_16x16x32_bf16 a[52:55], v[32:35], v[44:47], a[52:55]
    v_mfma_f32_16x16x32_bf16 a[56:59], v[32:35], v[48:51], a[56:59]
    v_mfma_f32_16x16x32_bf16 a[60:63], v[32:35], v[52:55], a[60:63]
    buffer_load_dwordx4 v[32:35], v4, s[24:27], s60 offen offset:3072
    v_mfma_f32_16x16x32_bf16 a[64:67], v[36:39], v[40:43], a[64:67]
    v_mfma_f32_16x16x32_bf16 a[68:71], v[36:39], v[44:47], a[68:71]
    v_mfma_f32_16x16x32_bf16 a[72:75], v[36:39], v[48:51], a[72:75]
    v_mfma_f32_16x16x32_bf16 a[76:79], v[36:39], v[52:55], a[76:79]
    buffer_load_dwordx4 v[36:39], v5, s[24:27], s60 offen offset:0
    buffer_load_dwordx4 v[40:43], v4, s[24:27], s59 offen offset:0
    buffer_load_dwordx4 v[44:47], v4, s[24:27], s59 offen offset:1024
    buffer_load_dwordx4 v[48:51], v4, s[24:27], s59 offen offset:2048
    buffer_load_dwordx4 v[52:55], v4, s[24:27], s59 offen offset:3072
    s_waitcnt vmcnt(27)
    s_nop 0
    s_add_u32 s70, s67, 9
    s_cmp_lt_i32 s70, 0
    s_cselect_b32 s71, 12, 0
    s_add_u32 s70, s70, s71
    s_cmp_ge_i32 s70, 12
    s_cselect_b32 s71, 12, 0
    s_sub_u32 s70, s70, s71
    s_lshl_b32 s71, s70, 12
    s_add_u32 s59, s54, s71
    s_mul_i32 s71, s70, 5120
    s_add_u32 s60, s55, s71
    v_mfma_f32_16x16x32_bf16 a[0:3], v[56:59], v[76:79], a[0:3]
    v_mfma_f32_16x16x32_bf16 a[4:7], v[56:59], v[80:83], a[4:7]
    v_mfma_f32_16x16x32_bf16 a[8:11], v[56:59], v[84:87], a[8:11]
    v_mfma_f32_16x16x32_bf16 a[12:15], v[56:59], v[88:91], a[12:15]
    buffer_load_dwordx4 v[56:59], v4, s[24:27], s60 offen offset:0
    v_mfma_f32_16x16x32_bf16 a[16:19], v[60:63], v[76:79], a[16:19]
    v_mfma_f32_16x16x32_bf16 a[20:23], v[60:63], v[80:83], a[20:23]
    v_mfma_f32_16x16x32_bf16 a[24:27], v[60:63], v[84:87], a[24:27]
    v_mfma_f32_16x16x32_bf16 a[28:31], v[60:63], v[88:91], a[28:31]
    buffer_load_dwordx4 v[60:63], v4, s[24:27], s60 offen offset:1024
    v_mfma_f32_16x16x32_bf16 a[32:35], v[64:67], v[76:79], a[32:35]
    v_mfma_f32_16x16x32_bf16 a[36:39], v[64:67], v[80:83], a[36:39]
    v_mfma_f32_16x16x32_bf16 a[40:43], v[64:67], v[84:87], a[40:43]
    v_mfma_f32_16x16x32_bf16 a[44:47], v[64:67], v[88:91], a[44:47]
    buffer_load_dwordx4 v[64:67], v4, s[24:27], s60 offen offset:2048
    v_mfma_f32_16x16x32_bf16 a[48:51], v[68:71], v[76:79], a[48:51]
    v_mfma_f32_16x16x32_bf16 a[52:55], v[68:71], v[80:83], a[52:55]
    v_mfma_f32_16x16x32_bf16 a[56:59], v[68:71], v[84:87], a[56:59]
    v_mfma_f32_16x16x32_bf16 a[60:63], v[68:71], v[88:91], a[60:63]
    buffer_load_dwordx4 v[68:71], v4, s[24:27], s60 offen offset:3072
    v_mfma_f32_16x16x32_bf16 a[64:67], v[72:75], v[76:79], a[64:67]
    v_mfma_f32_16x16x32_bf16 a[68:71], v[72:75], v[80:83], a[68:71]
    v_mfma_f32_16x16x32_bf16 a[72:75], v[72:75], v[84:87], a[72:75]
    v_mfma_f32_16x16x32_bf16 a[76:79], v[72:75], v[88:91], a[76:79]
    buffer_load_dwordx4 v[72:75], v5, s[24:27], s60 offen offset:0
    buffer_load_dwordx4 v[76:79], v4, s[24:27], s59 offen offset:0
    buffer_load_dwordx4 v[80:83], v4, s[24:27], s59 offen offset:1024
    buffer_load_dwordx4 v[84:87], v4, s[24:27], s59 offen offset:2048
    buffer_load_dwordx4 v[88:91], v4, s[24:27], s59 offen offset:3072
    s_waitcnt vmcnt(27)
    s_nop 0
    s_add_u32 s70, s68, 10
    s_cmp_lt_i32 s70, 0
    s_cselect_b32 s71, 12, 0
    s_add_u32 s70, s70, s71
    s_cmp_ge_i32 s70, 12
    s_cselect_b32 s71, 12, 0
    s_sub_u32 s70, s70, s71
    s_lshl_b32 s71, s70, 12
    s_add_u32 s59, s54, s71
    s_mul_i32 s71, s70, 5120
    s_add_u32 s60, s55, s71
    v_mfma_f32_16x16x32_bf16 a[0:3], v[92:95], v[112:115], a[0:3]
    v_mfma_f32_16x16x32_bf16 a[4:7], v[92:95], v[116:119], a[4:7]
    v_mfma_f32_16x16x32_bf16 a[8:11], v[92:95], v[120:123], a[8:11]
    v_mfma_f32_16x16x32_bf16 a[12:15], v[92:95], v[124:127], a[12:15]
    buffer_load_dwordx4 v[92:95], v4, s[24:27], s60 offen offset:0
    v_mfma_f32_16x16x32_bf16 a[16:19], v[96:99], v[112:115], a[16:19]
    v_mfma_f32_16x16x32_bf16 a[20:23], v[96:99], v[116:119], a[20:23]
    v_mfma_f32_16x16x32_bf16 a[24:27], v[96:99], v[120:123], a[24:27]
    v_mfma_f32_16x16x32_bf16 a[28:31], v[96:99], v[124:127], a[28:31]
    buffer_load_dwordx4 v[96:99], v4, s[24:27], s60 offen offset:1024
    v_mfma_f32_16x16x32_bf16 a[32:35], v[100:103], v[112:115], a[32:35]
    v_mfma_f32_16x16x32_bf16 a[36:39], v[100:103], v[116:119], a[36:39]
    v_mfma_f32_16x16x32_bf16 a[40:43], v[100:103], v[120:123], a[40:43]
    v_mfma_f32_16x16x32_bf16 a[44:47], v[100:103], v[124:127], a[44:47]
    buffer_load_dwordx4 v[100:103], v4, s[24:27], s60 offen offset:2048
    v_mfma_f32_16x16x32_bf16 a[48:51], v[104:107], v[112:115], a[48:51]
    v_mfma_f32_16x16x32_bf16 a[52:55], v[104:107], v[116:119], a[52:55]
    v_mfma_f32_16x16x32_bf16 a[56:59], v[104:107], v[120:123], a[56:59]
    v_mfma_f32_16x16x32_bf16 a[60:63], v[104:107], v[124:127], a[60:63]
    buffer_load_dwordx4 v[104:107], v4, s[24:27], s60 offen offset:3072
    v_mfma_f32_16x16x32_bf16 a[64:67], v[108:111], v[112:115], a[64:67]
    v_mfma_f32_16x16x32_bf16 a[68:71], v[108:111], v[116:119], a[68:71]
    v_mfma_f32_16x16x32_bf16 a[72:75], v[108:111], v[120:123], a[72:75]
    v_mfma_f32_16x16x32_bf16 a[76:79], v[108:111], v[124:127], a[76:79]
    buffer_load_dwordx4 v[108:111], v5, s[24:27], s60 offen offset:0
    buffer_load_dwordx4 v[112:115], v4, s[24:27], s59 offen offset:0
    buffer_load_dwordx4 v[116:119], v4, s[24:27], s59 offen offset:1024
    buffer_load_dwordx4 v[120:123], v4, s[24:27], s59 offen offset:2048
    buffer_load_dwordx4 v[124:127], v4, s[24:27], s59 offen offset:3072
    s_waitcnt vmcnt(27)
    buffer_load_dword v9, v8, s[24:27], s63 offen sc1
    s_nop 0
    s_add_u32 s70, s69, 11
    s_cmp_lt_i32 s70, 0
    s_cselect_b32 s71, 12, 0
    s_add_u32 s70, s70, s71
    s_cmp_ge_i32 s70, 12
    s_cselect_b32 s71, 12, 0
    s_sub_u32 s70, s70, s71
    s_lshl_b32 s71, s70, 12
    s_add_u32 s59, s54, s71
    s_mul_i32 s71, s70, 5120
    s_add_u32 s60, s55, s71
    v_mfma_f32_16x16x32_bf16 a[0:3], a[80:83], a[100:103], a[0:3]
    v_mfma_f32_16x16x32_bf16 a[4:7], a[80:83], a[104:107], a[4:7]
    v_mfma_f32_16x16x32_bf16 a[8:11], a[80:83], a[108:111], a[8:11]
    v_mfma_f32_16x16x32_bf16 a[12:15], a[80:83], a[112:115], a[12:15]
    buffer_load_dwordx4 a[80:83], v4, s[24:27], s60 offen offset:0
    v_mfma_f32_16x16x32_bf16 a[16:19], a[84:87], a[100:103], a[16:19]
    v_mfma_f32_16x16x32_bf16 a[20:23], a[84:87], a[104:107], a[20:23]
    v_mfma_f32_16x16x32_bf16 a[24:27], a[84:87], a[108:111], a[24:27]
    v_mfma_f32_16x16x32_bf16 a[28:31], a[84:87], a[112:115], a[28:31]
    buffer_load_dwordx4 a[84:87], v4, s[24:27], s60 offen offset:1024
    v_mfma_f32_16x16x32_bf16 a[32:35], a[88:91], a[100:103], a[32:35]
    v_mfma_f32_16x16x32_bf16 a[36:39], a[88:91], a[104:107], a[36:39]
    v_mfma_f32_16x16x32_bf16 a[40:43], a[88:91], a[108:111], a[40:43]
    v_mfma_f32_16x16x32_bf16 a[44:47], a[88:91], a[112:115], a[44:47]
    buffer_load_dwordx4 a[88:91], v4, s[24:27], s60 offen offset:2048
    v_mfma_f32_16x16x32_bf16 a[48:51], a[92:95], a[100:103], a[48:51]
    v_mfma_f32_16x16x32_bf16 a[52:55], a[92:95], a[104:107], a[52:55]
    v_mfma_f32_16x16x32_bf16 a[56:59], a[92:95], a[108:111], a[56:59]
    v_mfma_f32_16x16x32_bf16 a[60:63], a[92:95], a[112:115], a[60:63]
    buffer_load_dwordx4 a[92:95], v4, s[24:27], s60 offen offset:3072
    v_mfma_f32_16x16x32_bf16 a[64:67], a[96:99], a[100:103], a[64:67]
    v_mfma_f32_16x16x32_bf16 a[68:71], a[96:99], a[104:107], a[68:71]
    v_mfma_f32_16x16x32_bf16 a[72:75], a[96:99], a[108:111], a[72:75]
    v_mfma_f32_16x16x32_bf16 a[76:79], a[96:99], a[112:115], a[76:79]
    buffer_load_dwordx4 a[96:99], v5, s[24:27], s60 offen offset:0
    buffer_load_dwordx4 a[100:103], v4, s[24:27], s59 offen offset:0
    buffer_load_dwordx4 a[104:107], v4, s[24:27], s59 offen offset:1024
    buffer_load_dwordx4 a[108:111], v4, s[24:27], s59 offen offset:2048
    buffer_load_dwordx4 a[112:115], v4, s[24:27], s59 offen offset:3072
    s_waitcnt vmcnt(28)
    s_add_u32 s60, s55, 61440
    s_add_u32 s59, s54, 49152
    v_mfma_f32_16x16x32_bf16 a[0:3], v[20:23], v[40:43], a[0:3]
    v_mfma_f32_16x16x32_bf16 a[4:7], v[20:23], v[44:47], a[4:7]
    v_mfma_f32_16x16x32_bf16 a[8:11], v[20:23], v[48:51], a[8:11]
    v_mfma_f32_16x16x32_bf16 a[12:15], v[20:23], v[52:55], a[12:15]
    buffer_load_dwordx4 v[20:23], v4, s[24:27], s60 offen offset:0
    v_mfma_f32_16x16x32_bf16 a[16:19], v[24:27], v[40:43], a[16:19]
    v_mfma_f32_16x16x32_bf16 a[20:23], v[24:27], v[44:47], a[20:23]
    v_mfma_f32_16x16x32_bf16 a[24:27], v[24:27], v[48:51], a[24:27]
    v_mfma_f32_16x16x32_bf16 a[28:31], v[24:27], v[52:55], a[28:31]
    buffer_load_dwordx4 v[24:27], v4, s[24:27], s60 offen offset:1024
    v_mfma_f32_16x16x32_bf16 a[32:35], v[28:31], v[40:43], a[32:35]
    v_mfma_f32_16x16x32_bf16 a[36:39], v[28:31], v[44:47], a[36:39]
    v_mfma_f32_16x16x32_bf16 a[40:43], v[28:31], v[48:51], a[40:43]
    v_mfma_f32_16x16x32_bf16 a[44:47], v[28:31], v[52:55], a[44:47]
    buffer_load_dwordx4 v[28:31], v4, s[24:27], s60 offen offset:2048
    v_mfma_f32_16x16x32_bf16 a[48:51], v[32:35], v[40:43], a[48:51]
    v_mfma_f32_16x16x32_bf16 a[52:55], v[32:35], v[44:47], a[52:55]
    v_mfma_f32_16x16x32_bf16 a[56:59], v[32:35], v[48:51], a[56:59]
    v_mfma_f32_16x16x32_bf16 a[60:63], v[32:35], v[52:55], a[60:63]
    buffer_load_dwordx4 v[32:35], v4, s[24:27], s60 offen offset:3072
    v_mfma_f32_16x16x32_bf16 a[64:67], v[36:39], v[40:43], a[64:67]
    v_mfma_f32_16x16x32_bf16 a[68:71], v[36:39], v[44:47], a[68:71]
    v_mfma_f32_16x16x32_bf16 a[72:75], v[36:39], v[48:51], a[72:75]
    v_mfma_f32_16x16x32_bf16 a[76:79], v[36:39], v[52:55], a[76:79]
    buffer_load_dwordx4 v[36:39], v5, s[24:27], s60 offen offset:0
    buffer_load_dwordx4 v[40:43], v4, s[24:27], s59 offen offset:0
    buffer_load_dwordx4 v[44:47], v4, s[24:27], s59 offen offset:1024
    buffer_load_dwordx4 v[48:51], v4, s[24:27], s59 offen offset:2048
    buffer_load_dwordx4 v[52:55], v4, s[24:27], s59 offen offset:3072
    s_waitcnt vmcnt(28)
    s_add_u32 s60, s55, 66560
    s_mov_b32 s59, s58
    v_mfma_f32_16x16x32_bf16 a[0:3], v[56:59], v[76:79], a[0:3]
    v_mfma_f32_16x16x32_bf16 a[4:7], v[56:59], v[80:83], a[4:7]
    v_mfma_f32_16x16x32_bf16 a[8:11], v[56:59], v[84:87], a[8:11]
    v_mfma_f32_16x16x32_bf16 a[12:15], v[56:59], v[88:91], a[12:15]
    buffer_load_dwordx4 v[56:59], v4, s[24:27], s60 offen offset:0
    v_mfma_f32_16x16x32_bf16 a[16:19], v[60:63], v[76:79], a[16:19]
    v_mfma_f32_16x16x32_bf16 a[20:23], v[60:63], v[80:83], a[20:23]
    v_mfma_f32_16x16x32_bf16 a[24:27], v[60:63], v[84:87], a[24:27]
    v_mfma_f32_16x16x32_bf16 a[28:31], v[60:63], v[88:91], a[28:31]
    buffer_load_dwordx4 v[60:63], v4, s[24:27], s60 offen offset:1024
    v_mfma_f32_16x16x32_bf16 a[32:35], v[64:67], v[76:79], a[32:35]
    v_mfma_f32_16x16x32_bf16 a[36:39], v[64:67], v[80:83], a[36:39]
    v_mfma_f32_16x16x32_bf16 a[40:43], v[64:67], v[84:87], a[40:43]
    v_mfma_f32_16x16x32_bf16 a[44:47], v[64:67], v[88:91], a[44:47]
    buffer_load_dwordx4 v[64:67], v4, s[24:27], s60 offen offset:2048
    v_mfma_f32_16x16x32_bf16 a[48:51], v[68:71], v[76:79], a[48:51]
    v_mfma_f32_16x16x32_bf16 a[52:55], v[68:71], v[80:83], a[52:55]
    v_mfma_f32_16x16x32_bf16 a[56:59], v[68:71], v[84:87], a[56:59]
    v_mfma_f32_16x16x32_bf16 a[60:63], v[68:71], v[88:91], a[60:63]
    buffer_load_dwordx4 v[68:71], v4, s[24:27], s60 offen offset:3072
    v_mfma_f32_16x16x32_bf16 a[64:67], v[72:75], v[76:79], a[64:67]
    v_mfma_f32_16x16x32_bf16 a[68:71], v[72:75], v[80:83], a[68:71]
    v_mfma_f32_16x16x32_bf16 a[72:75], v[72:75], v[84:87], a[72:75]
    v_mfma_f32_16x16x32_bf16 a[76:79], v[72:75], v[88:91], a[76:79]
    buffer_load_dwordx4 v[72:75], v5, s[24:27], s60 offen offset:0
    buffer_load_dwordx4 v[76:79], v4, s[24:27], s59 offen offset:0
    buffer_load_dwordx4 v[80:83], v4, s[24:27], s59 offen offset:1024
    buffer_load_dwordx4 v[84:87], v4, s[24:27], s59 offen offset:2048
    buffer_load_dwordx4 v[88:91], v4, s[24:27], s59 offen offset:3072
    s_waitcnt vmcnt(28)
    s_nop 0
    s_add_u32 s70, s68, 0
    s_cmp_lt_i32 s70, 0
    s_cselect_b32 s71, 4, 0
    s_add_u32 s70, s70, s71
    s_cmp_ge_i32 s70, 4
    s_cselect_b32 s71, 4, 0
    s_sub_u32 s70, s70, s71
    s_lshl_b32 s71, s70, 12
    s_add_u32 s59, s56, s71
    s_mul_i32 s71, s70, 5120
    s_add_u32 s60, s57, s71
    v_mfma_f32_16x16x32_bf16 a[0:3], v[92:95], v[112:115], a[0:3]
    v_mfma_f32_16x16x32_bf16 a[4:7], v[92:95], v[116:119], a[4:7]
    v_mfma_f32_16x16x32_bf16 a[8:11], v[92:95], v[120:123], a[8:11]
    v_mfma_f32_16x16x32_bf16 a[12:15], v[92:95], v[124:127], a[12:15]
    buffer_load_dwordx4 v[92:95], v4, s[24:27], s60 offen offset:0
    v_mfma_f32_16x16x32_bf16 a[16:19], v[96:99], v[112:115], a[16:19]
    v_mfma_f32_16x16x32_bf16 a[20:23], v[96:99], v[116:119], a[20:23]
    v_mfma_f32_16x16x32_bf16 a[24:27], v[96:99], v[120:123], a[24:27]
    v_mfma_f32_16x16x32_bf16 a[28:31], v[96:99], v[124:127], a[28:31]
    buffer_load_dwordx4 v[96:99], v4, s[24:27], s60 offen offset:1024
    v_mfma_f32_16x16x32_bf16 a[32:35], v[100:103], v[112:115], a[32:35]
    v_mfma_f32_16x16x32_bf16 a[36:39], v[100:103], v[116:119], a[36:39]
    v_mfma_f32_16x16x32_bf16 a[40:43], v[100:103], v[120:123], a[40:43]
    v_mfma_f32_16x16x32_bf16 a[44:47], v[100:103], v[124:127], a[44:47]
    buffer_load_dwordx4 v[100:103], v4, s[24:27], s60 offen offset:2048
    v_mfma_f32_16x16x32_bf16 a[48:51], v[104:107], v[112:115], a[48:51]
    v_mfma_f32_16x16x32_bf16 a[52:55], v[104:107], v[116:119], a[52:55]
    v_mfma_f32_16x16x32_bf16 a[56:59], v[104:107], v[120:123], a[56:59]
    v_mfma_f32_16x16x32_bf16 a[60:63], v[104:107], v[124:127], a[60:63]
    buffer_load_dwordx4 v[104:107], v4, s[24:27], s60 offen offset:3072
    v_mfma_f32_16x16x32_bf16 a[64:67], v[108:111], v[112:115], a[64:67]
    v_mfma_f32_16x16x32_bf16 a[68:71], v[108:111], v[116:119], a[68:71]
    v_mfma_f32_16x16x32_bf16 a[72:75], v[108:111], v[120:123], a[72:75]
    v_mfma_f32_16x16x32_bf16 a[76:79], v[108:111], v[124:127], a[76:79]
    buffer_load_dwordx4 v[108:111], v5, s[24:27], s60 offen offset:0
    s_waitcnt vmcnt(23)
    v_cmp_ne_u32 vcc, 1, v9
    s_nop 4
    s_cbranch_vccz K2_READY
    s_mov_b32 s65, 200000
K2_SPIN:
    s_sub_u32 s65, s65, 1
    s_cbranch_scc1 K2_READY
    s_sleep 8
    buffer_load_dword v9, v8, s[24:27], s63 offen sc1
    s_waitcnt vmcnt(0)
    v_cmp_ne_u32 vcc, 1, v9
    s_nop 4
    s_cbranch_vccnz K2_SPIN
K2_READY:
    s_nop 0
    s_add_u32 s70, s69, 1
    s_cmp_lt_i32 s70, 0
    s_cselect_b32 s71, 4, 0
    s_add_u32 s70, s70, s71
    s_cmp_ge_i32 s70, 4
    s_cselect_b32 s71, 4, 0
    s_sub_u32 s70, s70, s71
    s_lshl_b32 s71, s70, 12
    s_add_u32 s59, s56, s71
    s_mul_i32 s71, s70, 5120
    s_add_u32 s60, s57, s71
    v_mfma_f32_16x16x32_bf16 a[0:3], a[80:83], a[100:103], a[0:3]
    v_mfma_f32_16x16x32_bf16 a[4:7], a[80:83], a[104:107], a[4:7]
    v_mfma_f32_16x16x32_bf16 a[8:11], a[80:83], a[108:111], a[8:11]
    v_mfma_f32_16x16x32_bf16 a[12:15], a[80:83], a[112:115], a[12:15]
    buffer_load_dwordx4 a[80:83], v4, s[24:27], s60 offen offset:0
    v_mfma_f32_16x16x32_bf16 a[16:19], a[84:87], a[100:103], a[16:19]
    v_mfma_f32_16x16x32_bf16 a[20:23], a[84:87], a[104:107], a[20:23]
    v_mfma_f32_16x16x32_bf16 a[24:27], a[84:87], a[108:111], a[24:27]
    v_mfma_f32_16x16x32_bf16 a[28:31], a[84:87], a[112:115], a[28:31]
    buffer_load_dwordx4 a[84:87], v4, s[24:27], s60 offen offset:1024
    v_mfma_f32_16x16x32_bf16 a[32:35], a[88:91], a[100:103], a[32:35]
    v_mfma_f32_16x16x32_bf16 a[36:39], a[88:91], a[104:107], a[36:39]
    v_mfma_f32_16x16x32_bf16 a[40:43], a[88:91], a[108:111], a[40:43]
    v_mfma_f32_16x16x32_bf16 a[44:47], a[88:91], a[112:115], a[44:47]
    buffer_load_dwordx4 a[88:91], v4, s[24:27], s60 offen offset:2048
    v_mfma_f32_16x16x32_bf16 a[48:51], a[92:95], a[100:103], a[48:51]
    v_mfma_f32_16x16x32_bf16 a[52:55], a[92:95], a[104:107], a[52:55]
    v_mfma_f32_16x16x32_bf16 a[56:59], a[92:95], a[108:111], a[56:59]
    v_mfma_f32_16x16x32_bf16 a[60:63], a[92:95], a[112:115], a[60:63]
    buffer_load_dwordx4 a[92:95], v4, s[24:27], s60 offen offset:3072
    v_mfma_f32_16x16x32_bf16 a[64:67], a[96:99], a[100:103], a[64:67]
    v_mfma_f32_16x16x32_bf16 a[68:71], a[96:99], a[104:107], a[68:71]
    v_mfma_f32_16x16x32_bf16 a[72:75], a[96:99], a[108:111], a[72:75]
    v_mfma_f32_16x16x32_bf16 a[76:79], a[96:99], a[112:115], a[76:79]
    buffer_load_dwordx4 a[96:99], v5, s[24:27], s60 offen offset:0
    s_add_u32 s70, s68, 0
    s_cmp_lt_i32 s70, 0
    s_cselect_b32 s71, 4, 0
    s_add_u32 s70, s70, s71
    s_cmp_ge_i32 s70, 4
    s_cselect_b32 s71, 4, 0
    s_sub_u32 s70, s70, s71
    s_lshl_b32 s71, s70, 12
    s_add_u32 s59, s56, s71
    s_mul_i32 s71, s70, 5120
    s_add_u32 s60, s57, s71
    buffer_load_dwordx2 v[112:113], v18, s[24:27], s59 offen offset:0 sc1
    buffer_load_dwordx2 v[114:115], v18, s[24:27], s59 offen offset:512 sc1
    buffer_load_dwordx2 v[116:117], v18, s[24:27], s59 offen offset:1024 sc1
    buffer_load_dwordx2 v[118:119], v18, s[24:27], s59 offen offset:1536 sc1
    buffer_load_dwordx2 v[120:121], v18, s[24:27], s59 offen offset:2048 sc1
    buffer_load_dwordx2 v[122:123], v18, s[24:27], s59 offen offset:2560 sc1
    buffer_load_dwordx2 v[124:125], v18, s[24:27], s59 offen offset:3072 sc1
    buffer_load_dwordx2 v[126:127], v18, s[24:27], s59 offen offset:3584 sc1
    s_waitcnt vmcnt(27)
    s_nop 0
    s_add_u32 s70, s66, 2
    s_cmp_lt_i32 s70, 0
    s_cselect_b32 s71, 4, 0
    s_add_u32 s70, s70, s71
    s_cmp_ge_i32 s70, 4
    s_cselect_b32 s71, 4, 0
    s_sub_u32 s70, s70, s71
    s_lshl_b32 s71, s70, 12
    s_add_u32 s59, s56, s71
    s_mul_i32 s71, s70, 5120
    s_add_u32 s60, s57, s71
    v_mfma_f32_16x16x32_bf16 a[0:3], v[20:23], v[40:43], a[0:3]
    v_mfma_f32_16x16x32_bf16 a[4:7], v[20:23], v[44:47], a[4:7]
    v_mfma_f32_16x16x32_bf16 a[8:11], v[20:23], v[48:51], a[8:11]
    v_mfma_f32_16x16x32_bf16 a[12:15], v[20:23], v[52:55], a[12:15]
    buffer_load_dwordx4 v[20:23], v4, s[24:27], s60 offen offset:0
    v_mfma_f32_16x16x32_bf16 a[16:19], v[24:27], v[40:43], a[16:19]
    v_mfma_f32_16x16x32_bf16 a[20:23], v[24:27], v[44:47], a[20:23]
    v_mfma_f32_16x16x32_bf16 a[24:27], v[24:27], v[48:51], a[24:27]
    v_mfma_f32_16x16x32_bf16 a[28:31], v[24:27], v[52:55], a[28:31]
    buffer_load_dwordx4 v[24:27], v4, s[24:27], s60 offen offset:1024
    v_mfma_f32_16x16x32_bf16 a[32:35], v[28:31], v[40:43], a[32:35]
    v_mfma_f32_16x16x32_bf16 a[36:39], v[28:31], v[44:47], a[36:39]
    v_mfma_f32_16x16x32_bf16 a[40:43], v[28:31], v[48:51], a[40:43]
    v_mfma_f32_16x16x32_bf16 a[44:47], v[28:31], v[52:55], a[44:47]
    buffer_load_dwordx4 v[28:31], v4, s[24:27], s60 offen offset:2048
    v_mfma_f32_16x16x32_bf16 a[48:51], v[32:35], v[40:43], a[48:51]
    v_mfma_f32_16x16x32_bf16 a[52:55], v[32:35], v[44:47], a[52:55]
    v_mfma_f32_16x16x32_bf16 a[56:59], v[32:35], v[48:51], a[56:59]
    v_mfma_f32_16x16x32_bf16 a[60:63], v[32:35], v[52:55], a[60:63]
    buffer_load_dwordx4 v[32:35], v4, s[24:27], s60 offen offset:3072
    v_mfma_f32_16x16x32_bf16 a[64:67], v[36:39], v[40:43], a[64:67]
    v_mfma_f32_16x16x32_bf16 a[68:71], v[36:39], v[44:47], a[68:71]
    v_mfma_f32_16x16x32_bf16 a[72:75], v[36:39], v[48:51], a[72:75]
    v_mfma_f32_16x16x32_bf16 a[76:79], v[36:39], v[52:55], a[76:79]
    buffer_load_dwordx4 v[36:39], v5, s[24:27], s60 offen offset:0
    s_add_u32 s70, s69, 1
    s_cmp_lt_i32 s70, 0
    s_cselect_b32 s71, 4, 0
    s_add_u32 s70, s70, s71
    s_cmp_ge_i32 s70, 4
    s_cselect_b32 s71, 4, 0
    s_sub_u32 s70, s70, s71
    s_lshl_b32 s71, s70, 12
    s_add_u32 s59, s56, s71
    s_mul_i32 s71, s70, 5120
    s_add_u32 s60, s57, s71
    buffer_load_dwordx2 a[100:101], v18, s[24:27], s59 offen offset:0 sc1
    buffer_load_dwordx2 a[102:103], v18, s[24:27], s59 offen offset:512 sc1
    buffer_load_dwordx2 a[104:105], v18, s[24:27], s59 offen offset:1024 sc1
    buffer_load_dwordx2 a[106:107], v18, s[24:27], s59 offen offset:1536 sc1
    buffer_load_dwordx2 a[108:109], v18, s[24:27], s59 offen offset:2048 sc1
    buffer_load_dwordx2 a[110:111], v18, s[24:27], s59 offen offset:2560 sc1
    buffer_load_dwordx2 a[112:113], v18, s[24:27], s59 offen offset:3072 sc1
    buffer_load_dwordx2 a[114:115], v18, s[24:27], s59 offen offset:3584 sc1
    s_waitcnt vmcnt(31)
    s_nop 0
    s_add_u32 s70, s67, 3
    s_cmp_lt_i32 s70, 0
    s_cselect_b32 s71, 4, 0
    s_add_u32 s70, s70, s71
    s_cmp_ge_i32 s70, 4
    s_cselect_b32 s71, 4, 0
    s_sub_u32 s70, s70, s71
    s_lshl_b32 s71, s70, 12
    s_add_u32 s59, s56, s71
    s_mul_i32 s71, s70, 5120
    s_add_u32 s60, s57, s71
    v_mfma_f32_16x16x32_bf16 a[0:3], v[56:59], v[76:79], a[0:3]
    v_mfma_f32_16x16x32_bf16 a[4:7], v[56:59], v[80:83], a[4:7]
    v_mfma_f32_16x16x32_bf16 a[8:11], v[56:59], v[84:87], a[8:11]
    v_mfma_f32_16x16x32_bf16 a[12:15], v[56:59], v[88:91], a[12:15]
    buffer_load_dwordx4 v[56:59], v4, s[24:27], s60 offen offset:0
    v_mfma_f32_16x16x32_bf16 a[16:19], v[60:63], v[76:79], a[16:19]
    v_mfma_f32_16x16x32_bf16 a[20:23], v[60:63], v[80:83], a[20:23]
    v_mfma_f32_16x16x32_bf16 a[24:27], v[60:63], v[84:87], a[24:27]
    v_mfma_f32_16x16x32_bf16 a[28:31], v[60:63], v[88:91], a[28:31]
    buffer_load_dwordx4 v[60:63], v4, s[24:27], s60 offen offset:1024
    v_mfma_f32_16x16x32_bf16 a[32:35], v[64:67], v[76:79], a[32:35]
    v_mfma_f32_16x16x32_bf16 a[36:39], v[64:67], v[80:83], a[36:39]
    v_mfma_f32_16x16x32_bf16 a[40:43], v[64:67], v[84:87], a[40:43]
    v_mfma_f32_16x16x32_bf16 a[44:47], v[64:67], v[88:91], a[44:47]
    buffer_load_dwordx4 v[64:67], v4, s[24:27], s60 offen offset:2048
    v_mfma_f32_16x16x32_bf16 a[48:51], v[68:71], v[76:79], a[48:51]
    v_mfma_f32_16x16x32_bf16 a[52:55], v[68:71], v[80:83], a[52:55]
    v_mfma_f32_16x16x32_bf16 a[56:59], v[68:71], v[84:87], a[56:59]
    v_mfma_f32_16x16x32_bf16 a[60:63], v[68:71], v[88:91], a[60:63]
    buffer_load_dwordx4 v[68:71], v4, s[24:27], s60 offen offset:3072
    v_mfma_f32_16x16x32_bf16 a[64:67], v[72:75], v[76:79], a[64:67]
    v_mfma_f32_16x16x32_bf16 a[68:71], v[72:75], v[80:83], a[68:71]
    v_mfma_f32_16x16x32_bf16 a[72:75], v[72:75], v[84:87], a[72:75]
    v_mfma_f32_16x16x32_bf16 a[76:79], v[72:75], v[88:91], a[76:79]
    buffer_load_dwordx4 v[72:75], v5, s[24:27], s60 offen offset:0
    s_add_u32 s70, s66, 2
    s_cmp_lt_i32 s70, 0
    s_cselect_b32 s71, 4, 0
    s_add_u32 s70, s70, s71
    s_cmp_ge_i32 s70, 4
    s_cselect_b32 s71, 4, 0
    s_sub_u32 s70, s70, s71
    s_lshl_b32 s71, s70, 12
    s_add_u32 s59, s56, s71
    s_mul_i32 s71, s70, 5120
    s_add_u32 s60, s57, s71
    buffer_load_dwordx2 v[40:41], v18, s[24:27], s59 offen offset:0 sc1
    buffer_load_dwordx2 v[42:43], v18, s[24:27], s59 offen offset:512 sc1
    buffer_load_dwordx2 v[44:45], v18, s[24:27], s59 offen offset:1024 sc1
    buffer_load_dwordx2 v[46:47], v18, s[24:27], s59 offen offset:1536 sc1
    buffer_load_dwordx2 v[48:49], v18, s[24:27], s59 offen offset:2048 sc1
    buffer_load_dwordx2 v[50:51], v18, s[24:27], s59 offen offset:2560 sc1
    buffer_load_dwordx2 v[52:53], v18, s[24:27], s59 offen offset:3072 sc1
    buffer_load_dwordx2 v[54:55], v18, s[24:27], s59 offen offset:3584 sc1
    s_waitcnt vmcnt(26)
    s_lshl_b32 s50, s45, 6
    s_lshl_b32 s51, s44, 4
    s_add_u32 s50, s50, s51
    s_mul_i32 s50, s50, 1280
    s_mul_i32 s51, s46, 160
    s_add_u32 s62, s50, s51
    v_mul_u32_u24 v10, 1280, v3
    v_lshl_add_u32 v11, v2, 3, v10
    v_lshl_add_u32 v10, v2, 4, v10
    buffer_load_dwordx4 a[116:119], v10, s[28:31], s62 offen
    buffer_load_dwordx4 a[120:123], v10, s[28:31], s62 offen offset:64
    buffer_load_dwordx2 a[124:125], v11, s[28:31], s62 offen offset:128
    s_add_u32 s60, s57, 20480
    s_add_u32 s59, s56, 16384
    v_mfma_f32_16x16x32_bf16 a[0:3], v[92:95], v[112:115], a[0:3]
    v_mfma_f32_16x16x32_bf16 a[4:7], v[92:95], v[116:119], a[4:7]
    v_mfma_f32_16x16x32_bf16 a[8:11], v[92:95], v[120:123], a[8:11]
    v_mfma_f32_16x16x32_bf16 a[12:15], v[92:95], v[124:127], a[12:15]
    buffer_load_dwordx4 v[92:95], v4, s[24:27], s60 offen offset:0
    v_mfma_f32_16x16x32_bf16 a[16:19], v[96:99], v[112:115], a[16:19]
    v_mfma_f32_16x16x32_bf16 a[20:23], v[96:99], v[116:119], a[20:23]
    v_mfma_f32_16x16x32_bf16 a[24:27], v[96:99], v[120:123], a[24:27]
    v_mfma_f32_16x16x32_bf16 a[28:31], v[96:99], v[124:127], a[28:31]
    buffer_load_dwordx4 v[96:99], v4, s[24:27], s60 offen offset:1024
    v_mfma_f32_16x16x32_bf16 a[32:35], v[100:103], v[112:115], a[32:35]
    v_mfma_f32_16x16x32_bf16 a[36:39], v[100:103], v[116:119], a[36:39]
    v_mfma_f32_16x16x32_bf16 a[40:43], v[100:103], v[120:123], a[40:43]
    v_mfma_f32_16x16x32_bf16 a[44:47], v[100:103], v[124:127], a[44:47]
    buffer_load_dwordx4 v[100:103], v4, s[24:27], s60 offen offset:2048
    v_mfma_f32_16x16x32_bf16 a[48:51], v[104:107], v[112:115], a[48:51]
    v_mfma_f32_16x16x32_bf16 a[52:55], v[104:107], v[116:119], a[52:55]
    v_mfma_f32_16x16x32_bf16 a[56:59], v[104:107], v[120:123], a[56:59]
    v_mfma_f32_16x16x32_bf16 a[60:63], v[104:107], v[124:127], a[60:63]
    buffer_load_dwordx4 v[104:107], v4, s[24:27], s60 offen offset:3072
    v_mfma_f32_16x16x32_bf16 a[64:67], v[108:111], v[112:115], a[64:67]
    v_mfma_f32_16x16x32_bf16 a[68:71], v[108:111], v[116:119], a[68:71]
    v_mfma_f32_16x16x32_bf16 a[72:75], v[108:111], v[120:123], a[72:75]
    v_mfma_f32_16x16x32_bf16 a[76:79], v[108:111], v[124:127], a[76:79]
    buffer_load_dwordx4 v[108:111], v5, s[24:27], s60 offen offset:0
    s_add_u32 s70, s67, 3
    s_cmp_lt_i32 s70, 0
    s_cselect_b32 s71, 4, 0
    s_add_u32 s70, s70, s71
    s_cmp_ge_i32 s70, 4
    s_cselect_b32 s71, 4, 0
    s_sub_u32 s70, s70, s71
    s_lshl_b32 s71, s70, 12
    s_add_u32 s59, s56, s71
    s_mul_i32 s71, s70, 5120
    s_add_u32 s60, s57, s71
    buffer_load_dwordx2 v[76:77], v18, s[24:27], s59 offen offset:0 sc1
    buffer_load_dwordx2 v[78:79], v18, s[24:27], s59 offen offset:512 sc1
    buffer_load_dwordx2 v[80:81], v18, s[24:27], s59 offen offset:1024 sc1
    buffer_load_dwordx2 v[82:83], v18, s[24:27], s59 offen offset:1536 sc1
    buffer_load_dwordx2 v[84:85], v18, s[24:27], s59 offen offset:2048 sc1
    buffer_load_dwordx2 v[86:87], v18, s[24:27], s59 offen offset:2560 sc1
    buffer_load_dwordx2 v[88:89], v18, s[24:27], s59 offen offset:3072 sc1
    buffer_load_dwordx2 v[90:91], v18, s[24:27], s59 offen offset:3584 sc1
    s_waitcnt vmcnt(29)
    v_mfma_f32_16x16x32_bf16 a[0:3], a[80:83], a[100:103], a[0:3]
    v_mfma_f32_16x16x32_bf16 a[4:7], a[80:83], a[104:107], a[4:7]
    v_mfma_f32_16x16x32_bf16 a[8:11], a[80:83], a[108:111], a[8:11]
    v_mfma_f32_16x16x32_bf16 a[12:15], a[80:83], a[112:115], a[12:15]
    v_mfma_f32_16x16x32_bf16 a[16:19], a[84:87], a[100:103], a[16:19]
    v_mfma_f32_16x16x32_bf16 a[20:23], a[84:87], a[104:107], a[20:23]
    v_mfma_f32_16x16x32_bf16 a[24:27], a[84:87], a[108:111], a[24:27]
    v_mfma_f32_16x16x32_bf16 a[28:31], a[84:87], a[112:115], a[28:31]
    v_mfma_f32_16x16x32_bf16 a[32:35], a[88:91], a[100:103], a[32:35]
    v_mfma_f32_16x16x32_bf16 a[36:39], a[88:91], a[104:107], a[36:39]
    v_mfma_f32_16x16x32_bf16 a[40:43], a[88:91], a[108:111], a[40:43]
    v_mfma_f32_16x16x32_bf16 a[44:47], a[88:91], a[112:115], a[44:47]
    v_mfma_f32_16x16x32_bf16 a[48:51], a[92:95], a[100:103], a[48:51]
    v_mfma_f32_16x16x32_bf16 a[52:55], a[92:95], a[104:107], a[52:55]
    v_mfma_f32_16x16x32_bf16 a[56:59], a[92:95], a[108:111], a[56:59]
    v_mfma_f32_16x16x32_bf16 a[60:63], a[92:95], a[112:115], a[60:63]
    v_mfma_f32_16x16x32_bf16 a[64:67], a[96:99], a[100:103], a[64:67]
    v_mfma_f32_16x16x32_bf16 a[68:71], a[96:99], a[104:107], a[68:71]
    v_mfma_f32_16x16x32_bf16 a[72:75], a[96:99], a[108:111], a[72:75]
    v_mfma_f32_16x16x32_bf16 a[76:79], a[96:99], a[112:115], a[76:79]
    s_add_u32 s59, s56, 16384
    buffer_load_dwordx2 v[112:113], v18, s[24:27], s59 offen offset:0 sc1
    buffer_load_dwordx2 v[114:115], v18, s[24:27], s59 offen offset:512 sc1
    buffer_load_dwordx2 v[116:117], v18, s[24:27], s59 offen offset:1024 sc1
    buffer_load_dwordx2 v[118:119], v18, s[24:27], s59 offen offset:1536 sc1
    buffer_load_dwordx2 v[120:121], v18, s[24:27], s59 offen offset:2048 sc1
    buffer_load_dwordx2 v[122:123], v18, s[24:27], s59 offen offset:2560 sc1
    buffer_load_dwordx2 v[124:125], v18, s[24:27], s59 offen offset:3072 sc1
    buffer_load_dwordx2 v[126:127], v18, s[24:27], s59 offen offset:3584 sc1
    s_waitcnt vmcnt(24)
    v_mfma_f32_16x16x32_bf16 a[0:3], v[20:23], v[40:43], a[0:3]
    v_mfma_f32_16x16x32_bf16 a[4:7], v[20:23], v[44:47], a[4:7]
    v_mfma_f32_16x16x32_bf16 a[8:11], v[20:23], v[48:51], a[8:11]
    v_mfma_f32_16x16x32_bf16 a[12:15], v[20:23], v[52:55], a[12:15]
    v_mfma_f32_16x16x32_bf16 a[16:19], v[24:27], v[40:43], a[16:19]
    v_mfma_f32_16x16x32_bf16 a[20:23], v[24:27], v[44:47], a[20:23]
    v_mfma_f32_16x16x32_bf16 a[24:27], v[24:27], v[48:51], a[24:27]
    v_mfma_f32_16x16x32_bf16 a[28:31], v[24:27], v[52:55], a[28:31]
    v_mfma_f32_16x16x32_bf16 a[32:35], v[28:31], v[40:43], a[32:35]
    v_mfma_f32_16x16x32_bf16 a[36:39], v[28:31], v[44:47], a[36:39]
    v_mfma_f32_16x16x32_bf16 a[40:43], v[28:31], v[48:51], a[40:43]
    v_mfma_f32_16x16x32_bf16 a[44:47], v[28:31], v[52:55], a[44:47]
    v_mfma_f32_16x16x32_bf16 a[48:51], v[32:35], v[40:43], a[48:51]
    v_mfma_f32_16x16x32_bf16 a[52:55], v[32:35], v[44:47], a[52:55]
    v_mfma_f32_16x16x32_bf16 a[56:59], v[32:35], v[48:51], a[56:59]
    v_mfma_f32_16x16x32_bf16 a[60:63], v[32:35], v[52:55], a[60:63]
    v_mfma_f32_16x16x32_bf16 a[64:67], v[36:39], v[40:43], a[64:67]
    v_mfma_f32_16x16x32_bf16 a[68:71], v[36:39], v[44:47], a[68:71]
    v_mfma_f32_16x16x32_bf16 a[72:75], v[36:39], v[48:51], a[72:75]
    v_mfma_f32_16x16x32_bf16 a[76:79], v[36:39], v[52:55], a[76:79]
    s_waitcnt vmcnt(8)
    v_mfma_f32_16x16x32_bf16 a[0:3], v[56:59], v[76:79], a[0:3]
    v_mfma_f32_16x16x32_bf16 a[4:7], v[56:59], v[80:83], a[4:7]
    v_mfma_f32_16x16x32_bf16 a[8:11], v[56:59], v[84:87], a[8:11]
    v_mfma_f32_16x16x32_bf16 a[12:15], v[56:59], v[88:91], a[12:15]
    v_mfma_f32_16x16x32_bf16 a[16:19], v[60:63], v[76:79], a[16:19]
    v_mfma_f32_16x16x32_bf16 a[20:23], v[60:63], v[80:83], a[20:23]
    v_mfma_f32_16x16x32_bf16 a[24:27], v[60:63], v[84:87], a[24:27]
    v_mfma_f32_16x16x32_bf16 a[28:31], v[60:63], v[88:91], a[28:31]
    v_mfma_f32_16x16x32_bf16 a[32:35], v[64:67], v[76:79], a[32:35]
    v_mfma_f32_16x16x32_bf16 a[36:39], v[64:67], v[80:83], a[36:39]
    v_mfma_f32_16x16x32_bf16 a[40:43], v[64:67], v[84:87], a[40:43]
    v_mfma_f32_16x16x32_bf16 a[44:47], v[64:67], v[88:91], a[44:47]
    v_mfma_f32_16x16x32_bf16 a[48:51], v[68:71], v[76:79], a[48:51]
    v_mfma_f32_16x16x32_bf16 a[52:55], v[68:71], v[80:83], a[52:55]
    v_mfma_f32_16x16x32_bf16 a[56:59], v[68:71], v[84:87], a[56:59]
    v_mfma_f32_16x16x32_bf16 a[60:63], v[68:71], v[88:91], a[60:63]
    v_mfma_f32_16x16x32_bf16 a[64:67], v[72:75], v[76:79], a[64:67]
    v_mfma_f32_16x16x32_bf16 a[68:71], v[72:75], v[80:83], a[68:71]
    v_mfma_f32_16x16x32_bf16 a[72:75], v[72:75], v[84:87], a[72:75]
    v_mfma_f32_16x16x32_bf16 a[76:79], v[72:75], v[88:91], a[76:79]
    s_waitcnt vmcnt(0)
    v_mfma_f32_16x16x32_bf16 a[0:3], v[92:95], v[112:115], a[0:3]
    v_mfma_f32_16x16x32_bf16 a[4:7], v[92:95], v[116:119], a[4:7]
    v_mfma_f32_16x16x32_bf16 a[8:11], v[92:95], v[120:123], a[8:11]
    v_mfma_f32_16x16x32_bf16 a[12:15], v[92:95], v[124:127], a[12:15]
    v_mfma_f32_16x16x32_bf16 a[16:19], v[96:99], v[112:115], a[16:19]
    v_mfma_f32_16x16x32_bf16 a[20:23], v[96:99], v[116:119], a[20:23]
    v_mfma_f32_16x16x32_bf16 a[24:27], v[96:99], v[120:123], a[24:27]
    v_mfma_f32_16x16x32_bf16 a[28:31], v[96:99], v[124:127], a[28:31]
    v_mfma_f32_16x16x32_bf16 a[32:35], v[100:103], v[112:115], a[32:35]
    v_mfma_f32_16x16x32_bf16 a[36:39], v[100:103], v[116:119], a[36:39]
    v_mfma_f32_16x16x32_bf16 a[40:43], v[100:103], v[120:123], a[40:43]
    v_mfma_f32_16x16x32_bf16 a[44:47], v[100:103], v[124:127], a[44:47]
    v_mfma_f32_16x16x32_bf16 a[48:51], v[104:107], v[112:115], a[48:51]
    v_mfma_f32_16x16x32_bf16 a[52:55], v[104:107], v[116:119], a[52:55]
    v_mfma_f32_16x16x32_bf16 a[56:59], v[104:107], v[120:123], a[56:59]
    v_mfma_f32_16x16x32_bf16 a[60:63], v[104:107], v[124:127], a[60:63]
    v_mfma_f32_16x16x32_bf16 a[64:67], v[108:111], v[112:115], a[64:67]
    v_mfma_f32_16x16x32_bf16 a[68:71], v[108:111], v[116:119], a[68:71]
    v_mfma_f32_16x16x32_bf16 a[72:75], v[108:111], v[120:123], a[72:75]
    v_mfma_f32_16x16x32_bf16 a[76:79], v[108:111], v[124:127], a[76:79]
    s_nop 7
    s_nop 1
    s_mul_i32 s50, s44, 5120
    v_add_u32 v6, s50, v4
    v_add_u32 v7, 40960, v6
    s_cmp_eq_u32 s44, 0
    s_cbranch_scc1 K2_SK_1
    ds_write_b128 v6, a[0:3] offset:0
    ds_write_b128 v6, a[16:19] offset:1024
    ds_write_b128 v6, a[32:35] offset:2048
    ds_write_b128 v6, a[48:51] offset:3072
    ds_write_b128 v6, a[64:67] offset:4096
K2_SK_1:
    s_cmp_eq_u32 s44, 1
    s_cbranch_scc1 K2_SK_2
    ds_write_b128 v6, a[4:7] offset:20480
    ds_write_b128 v6, a[20:23] offset:21504
    ds_write_b128 v6, a[36:39] offset:22528
    ds_write_b128 v6, a[52:55] offset:23552
    ds_write_b128 v6, a[68:71] offset:24576
K2_SK_2:
    s_cmp_eq_u32 s44, 2
    s_cbranch_scc1 K2_SK_3
    ds_write_b128 v7, a[8:11] offset:0
    ds_write_b128 v7, a[24:27] offset:1024
    ds_write_b128 v7, a[40:43] offset:2048
    ds_write_b128 v7, a[56:59] offset:3072
    ds_write_b128 v7, a[72:75] offset:4096
K2_SK_3:
    s_cmp_eq_u32 s44, 3
    s_cbranch_scc1 K2_SK_4
    ds_write_b128 v7, a[12:15] offset:20480
    ds_write_b128 v7, a[28:31] offset:21504
    ds_write_b128 v7, a[44:47] offset:22528
    ds_write_b128 v7, a[60:63] offset:23552
    ds_write_b128 v7, a[76:79] offset:24576
K2_SK_4:
    s_cmp_eq_u32 s44, 0
    s_cbranch_scc0 K2_OW_5
    v_accvgpr_read_b32 v20, a0
    v_accvgpr_read_b32 v21, a1
    v_accvgpr_read_b32 v22, a2
    v_accvgpr_read_b32 v23, a3
    v_accvgpr_read_b32 v24, a16
    v_accvgpr_read_b32 v25, a17
    v_accvgpr_read_b32 v26, a18
    v_accvgpr_read_b32 v27, a19
    v_accvgpr_read_b32 v28, a32
    v_accvgpr_read_b32 v29, a33
    v_accvgpr_read_b32 v30, a34
    v_accvgpr_read_b32 v31, a35
    v_accvgpr_read_b32 v32, a48
    v_accvgpr_read_b32 v33, a49
    v_accvgpr_read_b32 v34, a50
    v_accvgpr_read_b32 v35, a51
    v_accvgpr_read_b32 v36, a64
    v_accvgpr_read_b32 v37, a65
    v_accvgpr_read_b32 v38, a66
    v_accvgpr_read_b32 v39, a67
K2_OW_5:
    s_cmp_eq_u32 s44, 1
    s_cbranch_scc0 K2_OW_6
    v_accvgpr_read_b32 v20, a4
    v_accvgpr_read_b32 v21, a5
    v_accvgpr_read_b32 v22, a6
    v_accvgpr_read_b32 v23, a7
    v_accvgpr_read_b32 v24, a20
    v_accvgpr_read_b32 v25, a21
    v_accvgpr_read_b32 v26, a22
    v_accvgpr_read_b32 v27, a23
    v_accvgpr_read_b32 v28, a36
    v_accvgpr_read_b32 v29, a37
    v_accvgpr_read_b32 v30, a38
    v_accvgpr_read_b32 v31, a39
    v_accvgpr_read_b32 v32, a52
    v_accvgpr_read_b32 v33, a53
    v_accvgpr_read_b32 v34, a54
    v_accvgpr_read_b32 v35, a55
    v_accvgpr_read_b32 v36, a68
    v_accvgpr_read_b32 v37, a69
    v_accvgpr_read_b32 v38, a70
    v_accvgpr_read_b32 v39, a71
K2_OW_6:
    s_cmp_eq_u32 s44, 2
    s_cbranch_scc0 K2_OW_7
    v_accvgpr_read_b32 v20, a8
    v_accvgpr_read_b32 v21, a9
    v_accvgpr_read_b32 v22, a10
    v_accvgpr_read_b32 v23, a11
    v_accvgpr_read_b32 v24, a24
    v_accvgpr_read_b32 v25, a25
    v_accvgpr_read_b32 v26, a26
    v_accvgpr_read_b32 v27, a27
    v_accvgpr_read_b32 v28, a40
    v_accvgpr_read_b32 v29, a41
    v_accvgpr_read_b32 v30, a42
    v_accvgpr_read_b32 v31, a43
    v_accvgpr_read_b32 v32, a56
    v_accvgpr_read_b32 v33, a57
    v_accvgpr_read_b32 v34, a58
    v_accvgpr_read_b32 v35, a59
    v_accvgpr_read_b32 v36, a72
    v_accvgpr_read_b32 v37, a73
    v_accvgpr_read_b32 v38, a74
    v_accvgpr_read_b32 v39, a75
K2_OW_7:
    s_cmp_eq_u32 s44, 3
    s_cbranch_scc0 K2_OW_8
    v_accvgpr_read_b32 v20, a12
    v_accvgpr_read_b32 v21, a13
    v_accvgpr_read_b32 v22, a14
    v_accvgpr_read_b32 v23, a15
    v_accvgpr_read_b32 v24, a28
    v_accvgpr_read_b32 v25, a29
    v_accvgpr_read_b32 v26, a30
    v_accvgpr_read_b32 v27, a31
    v_accvgpr_read_b32 v28, a44
    v_accvgpr_read_b32 v29, a45
    v_accvgpr_read_b32 v30, a46
    v_accvgpr_read_b32 v31, a47
    v_accvgpr_read_b32 v32, a60
    v_accvgpr_read_b32 v33, a61
    v_accvgpr_read_b32 v34, a62
    v_accvgpr_read_b32 v35, a63
    v_accvgpr_read_b32 v36, a76
    v_accvgpr_read_b32 v37, a77
    v_accvgpr_read_b32 v38, a78
    v_accvgpr_read_b32 v39, a79
K2_OW_8:
    v_accvgpr_read_b32 v100, a116
    v_accvgpr_read_b32 v101, a117
    v_accvgpr_read_b32 v102, a118
    v_accvgpr_read_b32 v103, a119
    v_accvgpr_read_b32 v104, a120
    v_accvgpr_read_b32 v105, a121
    v_accvgpr_read_b32 v106, a122
    v_accvgpr_read_b32 v107, a123
    v_accvgpr_read_b32 v108, a124
    v_accvgpr_read_b32 v109, a125
    s_waitcnt lgkmcnt(0)
    s_barrier
    s_mul_i32 s50, s44, 20480
    v_add_u32 v6, s50, v4
    s_add_u32 s51, s44, 1
    s_and_b32 s51, s51, 3
    s_mul_i32 s51, s51, 5120
    v_add_u32 v7, s51, v6
    ds_read_b128 v[40:43], v7 offset:0
    ds_read_b128 v[44:47], v7 offset:1024
    ds_read_b128 v[48:51], v7 offset:2048
    ds_read_b128 v[52:55], v7 offset:3072
    ds_read_b128 v[56:59], v7 offset:4096
    s_add_u32 s51, s44, 2
    s_and_b32 s51, s51, 3
    s_mul_i32 s51, s51, 5120
    v_add_u32 v7, s51, v6
    ds_read_b128 v[60:63], v7 offset:0
    ds_read_b128 v[64:67], v7 offset:1024
    ds_read_b128 v[68:71], v7 offset:2048
    ds_read_b128 v[72:75], v7 offset:3072
    ds_read_b128 v[76:79], v7 offset:4096
    s_add_u32 s51, s44, 3
    s_and_b32 s51, s51, 3
    s_mul_i32 s51, s51, 5120
    v_add_u32 v7, s51, v6
    ds_read_b128 v[80:83], v7 offset:0
    ds_read_b128 v[84:87], v7 offset:1024
    ds_read_b128 v[88:91], v7 offset:2048
    ds_read_b128 v[92:95], v7 offset:3072
    ds_read_b128 v[96:99], v7 offset:4096
    v_lshlrev_b32 v12, 16, v100
    v_and_b32 v13, 0xffff0000, v100
    v_add_f32 v20, v20, v12
    v_add_f32 v21, v21, v13
    v_lshlrev_b32 v12, 16, v101
    v_and_b32 v13, 0xffff0000, v101
    v_add_f32 v22, v22, v12
    v_add_f32 v23, v23, v13
    v_lshlrev_b32 v12, 16, v102
    v_and_b32 v13, 0xffff0000, v102
    v_add_f32 v24, v24, v12
    v_add_f32 v25, v25, v13
    v_lshlrev_b32 v12, 16, v103
    v_and_b32 v13, 0xffff0000, v103
    v_add_f32 v26, v26, v12
    v_add_f32 v27, v27, v13
    v_lshlrev_b32 v12, 16, v104
    v_and_b32 v13, 0xffff0000, v104
    v_add_f32 v28, v28, v12
    v_add_f32 v29, v29, v13
    v_lshlrev_b32 v12, 16, v105
    v_and_b32 v13, 0xffff0000, v105
    v_add_f32 v30, v30, v12
    v_add_f32 v31, v31, v13
    v_lshlrev_b32 v12, 16, v106
    v_and_b32 v13, 0xffff0000, v106
    v_add_f32 v32, v32, v12
    v_add_f32 v33, v33, v13
    v_lshlrev_b32 v12, 16, v107
    v_and_b32 v13, 0xffff0000, v107
    v_add_f32 v34, v34, v12
    v_add_f32 v35, v35, v13
    v_lshlrev_b32 v12, 16, v108
    v_and_b32 v13, 0xffff0000, v108
    v_add_f32 v36, v36, v12
    v_add_f32 v37, v37, v13
    v_lshlrev_b32 v12, 16, v109
    v_and_b32 v13, 0xffff0000, v109
    v_add_f32 v38, v38, v12
    v_add_f32 v39, v39, v13
    s_waitcnt lgkmcnt(0)
    v_add_f32 v20, v20, v40
    v_add_f32 v21, v21, v41
    v_add_f32 v22, v22, v42
    v_add_f32 v23, v23, v43
    v_add_f32 v24, v24, v44
    v_add_f32 v25, v25, v45
    v_add_f32 v26, v26, v46
    v_add_f32 v27, v27, v47
    v_add_f32 v28, v28, v48
    v_add_f32 v29, v29, v49
    v_add_f32 v30, v30, v50
    v_add_f32 v31, v31, v51
    v_add_f32 v32, v32, v52
    v_add_f32 v33, v33, v53
    v_add_f32 v34, v34, v54
    v_add_f32 v35, v35, v55
    v_add_f32 v36, v36, v56
    v_add_f32 v37, v37, v57
    v_add_f32 v38, v38, v58
    v_add_f32 v39, v39, v59
    v_add_f32 v20, v20, v60
    v_add_f32 v21, v21, v61
    v_add_f32 v22, v22, v62
    v_add_f32 v23, v23, v63
    v_add_f32 v24, v24, v64
    v_add_f32 v25, v25, v65
    v_add_f32 v26, v26, v66
    v_add_f32 v27, v27, v67
    v_add_f32 v28, v28, v68
    v_add_f32 v29, v29, v69
    v_add_f32 v30, v30, v70
    v_add_f32 v31, v31, v71
    v_add_f32 v32, v32, v72
    v_add_f32 v33, v33, v73
    v_add_f32 v34, v34, v74
    v_add_f32 v35, v35, v75
    v_add_f32 v36, v36, v76
    v_add_f32 v37, v37, v77
    v_add_f32 v38, v38, v78
    v_add_f32 v39, v39, v79
    v_add_f32 v20, v20, v80
    v_add_f32 v21, v21, v81
    v_add_f32 v22, v22, v82
    v_add_f32 v23, v23, v83
    v_add_f32 v24, v24, v84
    v_add_f32 v25, v25, v85
    v_add_f32 v26, v26, v86
    v_add_f32 v27, v27, v87
    v_add_f32 v28, v28, v88
    v_add_f32 v29, v29, v89
    v_add_f32 v30, v30, v90
    v_add_f32 v31, v31, v91
    v_add_f32 v32, v32, v92
    v_add_f32 v33, v33, v93
    v_add_f32 v34, v34, v94
    v_add_f32 v35, v35, v95
    v_add_f32 v36, v36, v96
    v_add_f32 v37, v37, v97
    v_add_f32 v38, v38, v98
    v_add_f32 v39, v39, v99
    v_cvt_pk_bf16_f32 v112, v20, v21
    v_cvt_pk_bf16_f32 v113, v22, v23
    v_cvt_pk_bf16_f32 v114, v24, v25
    v_cvt_pk_bf16_f32 v115, v26, v27
    v_cvt_pk_bf16_f32 v116, v28, v29
    v_cvt_pk_bf16_f32 v117, v30, v31
    v_cvt_pk_bf16_f32 v118, v32, v33
    v_cvt_pk_bf16_f32 v119, v34, v35
    v_cvt_pk_bf16_f32 v120, v36, v37
    v_cvt_pk_bf16_f32 v121, v38, v39
    buffer_store_dwordx4 v[112:115], v10, s[32:35], s62 offen
    buffer_store_dwordx4 v[116:119], v10, s[32:35], s62 offen offset:64
    buffer_store_dwordx2 v[120:121], v11, s[32:35], s62 offen offset:128
    s_branch K2_END
K2_PROD:
    s_setprio 3
    s_mul_i32 s50, s47, 800
    s_add_u32 s36, s12, s50
    s_addc_u32 s37, s13, 0
    s_mov_b32 s38, 800
    s_mov_b32 s39, 0x20000
    s_mov_b32 m0, 83968
    s_nop 0
    buffer_load_dwordx4 v4, s[36:39], 0 offen lds
    s_lshl_b32 s50, s48, 2
    s_add_u32 s50, s50, s49
    s_mul_i32 s50, s50, 20
    s_mul_i32 s51, s47, 5
    v_lshlrev_b32 v7, 10, v2
    v_lshl_add_u32 v7, v3, 4, v7
    s_add_u32 s52, s51, 0
    s_lshr_b32 s53, s52, 3
    s_add_u32 s53, s53, s50
    s_lshl_b32 s53, s53, 12
    s_and_b32 s61, s52, 6
    s_lshl_b32 s61, s61, 7
    s_add_u32 s53, s53, s61
    s_lshr_b32 s61, s52, 1
    s_xor_b32 s61, s61, s52
    s_and_b32 s61, s61, 1
    s_lshl_b32 s61, s61, 3
    s_add_u32 s53, s53, s61
    s_add_u32 s53, s53, 7077888
    buffer_load_dwordx2 v[32:33], v7, s[24:27], s53 offen
    s_add_u32 s52, s51, 1
    s_lshr_b32 s53, s52, 3
    s_add_u32 s53, s53, s50
    s_lshl_b32 s53, s53, 12
    s_and_b32 s61, s52, 6
    s_lshl_b32 s61, s61, 7
    s_add_u32 s53, s53, s61
    s_lshr_b32 s61, s52, 1
    s_xor_b32 s61, s61, s52
    s_and_b32 s61, s61, 1
    s_lshl_b32 s61, s61, 3
    s_add_u32 s53, s53, s61
    s_add_u32 s53, s53, 7077888
    buffer_load_dwordx2 v[34:35], v7, s[24:27], s53 offen
    s_add_u32 s52, s51, 2
    s_lshr_b32 s53, s52, 3
    s_add_u32 s53, s53, s50
    s_lshl_b32 s53, s53, 12
    s_and_b32 s61, s52, 6
    s_lshl_b32 s61, s61, 7
    s_add_u32 s53, s53, s61
    s_lshr_b32 s61, s52, 1
    s_xor_b32 s61, s61, s52
    s_and_b32 s61, s61, 1
    s_lshl_b32 s61, s61, 3
    s_add_u32 s53, s53, s61
    s_add_u32 s53, s53, 7077888
    buffer_load_dwordx2 v[36:37], v7, s[24:27], s53 offen
    s_add_u32 s52, s51, 3
    s_lshr_b32 s53, s52, 3
    s_add_u32 s53, s53, s50
    s_lshl_b32 s53, s53, 12
    s_and_b32 s61, s52, 6
    s_lshl_b32 s61, s61, 7
    s_add_u32 s53, s53, s61
    s_lshr_b32 s61, s52, 1
    s_xor_b32 s61, s61, s52
    s_and_b32 s61, s61, 1
    s_lshl_b32 s61, s61, 3
    s_add_u32 s53, s53, s61
    s_add_u32 s53, s53, 7077888
    buffer_load_dwordx2 v[38:39], v7, s[24:27], s53 offen
    s_add_u32 s52, s51, 4
    s_lshr_b32 s53, s52, 3
    s_add_u32 s53, s53, s50
    s_lshl_b32 s53, s53, 12
    s_and_b32 s61, s52, 6
    s_lshl_b32 s61, s61, 7
    s_add_u32 s53, s53, s61
    s_lshr_b32 s61, s52, 1
    s_xor_b32 s61, s61, s52
    s_and_b32 s61, s61, 1
    s_lshl_b32 s61, s61, 3
    s_add_u32 s53, s53, s61
    s_add_u32 s53, s53, 7077888
    buffer_load_dwordx2 v[40:41], v7, s[24:27], s53 offen
    s_lshl_b32 s50, s49, 6
    v_add_u32 v14, s50, v1
    v_lshlrev_b32 v6, 3, v14
    v_mov_b32 v7, 2147483632
    v_cmp_gt_u32 vcc, 210, v14
    s_nop 1
    v_cndmask_b32 v6, v7, v6, vcc
    s_mul_i32 s50, s47, 1792
    s_add_u32 s50, s50, 9699328
    buffer_load_dwordx2 v[96:97], v6, s[24:27], s50 offen
    s_add_u32 s50, s50, 57344
    buffer_load_dwordx2 v[98:99], v6, s[24:27], s50 offen
    s_add_u32 s50, s50, 57344
    buffer_load_dwordx2 v[100:101], v6, s[24:27], s50 offen
    s_add_u32 s50, s50, 57344
    buffer_load_dwordx2 v[102:103], v6, s[24:27], s50 offen
    s_add_u32 s50, s50, 57344
    buffer_load_dwordx2 v[104:105], v6, s[24:27], s50 offen
    s_add_u32 s50, s50, 57344
    buffer_load_dwordx2 v[106:107], v6, s[24:27], s50 offen
    s_add_u32 s50, s50, 57344
    buffer_load_dwordx2 v[108:109], v6, s[24:27], s50 offen
    s_add_u32 s50, s50, 57344
    buffer_load_dwordx2 v[110:111], v6, s[24:27], s50 offen
    s_add_u32 s50, s50, 57344
    buffer_load_dwordx2 v[112:113], v6, s[24:27], s50 offen
    s_add_u32 s50, s50, 57344
    buffer_load_dwordx2 v[114:115], v6, s[24:27], s50 offen
    s_add_u32 s50, s50, 57344
    buffer_load_dwordx2 v[116:117], v6, s[24:27], s50 offen
    s_add_u32 s50, s50, 57344
    buffer_load_dwordx2 v[118:119], v6, s[24:27], s50 offen
    s_add_u32 s50, s50, 57344
    buffer_load_dwordx2 v[120:121], v6, s[24:27], s50 offen
    s_add_u32 s50, s50, 57344
    buffer_load_dwordx2 v[122:123], v6, s[24:27], s50 offen
    s_add_u32 s50, s50, 57344
    buffer_load_dwordx2 v[124:125], v6, s[24:27], s50 offen
    s_add_u32 s50, s50, 57344
    buffer_load_dwordx2 v[126:127], v6, s[24:27], s50 offen
    v_mov_b32 v42, 0
    v_mov_b32 v43, 0
    v_mov_b32 v8, 0
    v_mov_b32 v9, 0
    v_mov_b32 v10, 0
    v_mov_b32 v11, 0
    s_and_b32 s50, s49, 1
    s_lshl_b32 s50, s50, 10
    s_add_u32 s50, s50, 84992
    v_add_u32 v6, s50, v4
    ds_write_b128 v6, v[8:11]
    v_mov_b32 v6, 87040
    ds_write_b64 v6, v[8:9]
    s_waitcnt lgkmcnt(0)
    s_barrier
    v_bfe_u32 v16, v1, 2, 2
    v_and_b32 v17, 3, v1
    v_mul_u32_u24 v8, 40, v16
    v_add_u32 v8, 83968, v8
    v_mov_b32 v9, 84992
    v_cmp_eq_u32 vcc, v17, v2
    s_nop 1
    v_cndmask_b32 v8, v9, v8, vcc
    v_accvgpr_write_b32 a10, 0
    v_accvgpr_write_b32 a11, 0
    v_accvgpr_write_b32 a22, 0
    v_accvgpr_write_b32 a23, 0
    v_accvgpr_write_b32 a34, 0
    v_accvgpr_write_b32 a35, 0
    v_accvgpr_write_b32 a46, 0
    v_accvgpr_write_b32 a47, 0
    v_accvgpr_write_b32 a58, 0
    v_accvgpr_write_b32 a59, 0
    s_waitcnt vmcnt(21)
    ds_read_b64_tr_b16 a[0:1], v8 offset:0
    ds_read_b64_tr_b16 a[2:3], v8 offset:160
    ds_read_b64_tr_b16 a[4:5], v8 offset:320
    ds_read_b64_tr_b16 a[6:7], v8 offset:480
    ds_read_b64_tr_b16 a[8:9], v8 offset:640
    ds_read_b64_tr_b16 a[12:13], v8 offset:8
    ds_read_b64_tr_b16 a[14:15], v8 offset:168
    ds_read_b64_tr_b16 a[16:17], v8 offset:328
    ds_read_b64_tr_b16 a[18:19], v8 offset:488
    ds_read_b64_tr_b16 a[20:21], v8 offset:648
    ds_read_b64_tr_b16 a[24:25], v8 offset:16
    ds_read_b64_tr_b16 a[26:27], v8 offset:176
    ds_read_b64_tr_b16 a[28:29], v8 offset:336
    ds_read_b64_tr_b16 a[30:31], v8 offset:496
    ds_read_b64_tr_b16 a[32:33], v8 offset:656
    ds_read_b64_tr_b16 a[36:37], v8 offset:24
    ds_read_b64_tr_b16 a[38:39], v8 offset:184
    ds_read_b64_tr_b16 a[40:41], v8 offset:344
    ds_read_b64_tr_b16 a[42:43], v8 offset:504
    ds_read_b64_tr_b16 a[44:45], v8 offset:664
    ds_read_b64_tr_b16 a[48:49], v8 offset:32
    ds_read_b64_tr_b16 a[50:51], v8 offset:192
    ds_read_b64_tr_b16 a[52:53], v8 offset:352
    ds_read_b64_tr_b16 a[54:55], v8 offset:512
    ds_read_b64_tr_b16 a[56:57], v8 offset:672
    s_waitcnt vmcnt(16) lgkmcnt(0)
    s_nop 7
    v_mfma_f32_16x16x32_bf16 v[44:47], a[0:3], v[32:35], 0
    v_mfma_f32_16x16x32_bf16 v[48:51], a[12:15], v[32:35], 0
    v_mfma_f32_16x16x32_bf16 v[52:55], a[24:27], v[32:35], 0
    v_mfma_f32_16x16x32_bf16 v[56:59], a[36:39], v[32:35], 0
    v_mfma_f32_16x16x32_bf16 v[60:63], a[48:51], v[32:35], 0
    v_mfma_f32_16x16x32_bf16 v[44:47], a[4:7], v[36:39], v[44:47]
    v_mfma_f32_16x16x32_bf16 v[48:51], a[16:19], v[36:39], v[48:51]
    v_mfma_f32_16x16x32_bf16 v[52:55], a[28:31], v[36:39], v[52:55]
    v_mfma_f32_16x16x32_bf16 v[56:59], a[40:43], v[36:39], v[56:59]
    v_mfma_f32_16x16x32_bf16 v[60:63], a[52:55], v[36:39], v[60:63]
    v_mfma_f32_16x16x32_bf16 v[44:47], a[8:11], v[40:43], v[44:47]
    v_mfma_f32_16x16x32_bf16 v[48:51], a[20:23], v[40:43], v[48:51]
    v_mfma_f32_16x16x32_bf16 v[52:55], a[32:35], v[40:43], v[52:55]
    v_mfma_f32_16x16x32_bf16 v[56:59], a[44:47], v[40:43], v[56:59]
    v_mfma_f32_16x16x32_bf16 v[60:63], a[56:59], v[40:43], v[60:63]
    s_waitcnt vmcnt(0)
    v_lshlrev_b32 v64, 16, v96
    v_and_b32 v65, 0xffff0000, v96
    v_lshlrev_b32 v66, 16, v97
    v_and_b32 v67, 0xffff0000, v97
    v_lshlrev_b32 v72, 16, v98
    v_and_b32 v73, 0xffff0000, v98
    v_add_f32 v64, v64, v72
    v_add_f32 v65, v65, v73
    v_lshlrev_b32 v74, 16, v99
    v_and_b32 v75, 0xffff0000, v99
    v_add_f32 v66, v66, v74
    v_add_f32 v67, v67, v75
    v_lshlrev_b32 v68, 16, v100
    v_and_b32 v69, 0xffff0000, v100
    v_add_f32 v64, v64, v68
    v_add_f32 v65, v65, v69
    v_lshlrev_b32 v70, 16, v101
    v_and_b32 v71, 0xffff0000, v101
    v_add_f32 v66, v66, v70
    v_add_f32 v67, v67, v71
    v_lshlrev_b32 v72, 16, v102
    v_and_b32 v73, 0xffff0000, v102
    v_add_f32 v64, v64, v72
    v_add_f32 v65, v65, v73
    v_lshlrev_b32 v74, 16, v103
    v_and_b32 v75, 0xffff0000, v103
    v_add_f32 v66, v66, v74
    v_add_f32 v67, v67, v75
    v_lshlrev_b32 v68, 16, v104
    v_and_b32 v69, 0xffff0000, v104
    v_add_f32 v64, v64, v68
    v_add_f32 v65, v65, v69
    v_lshlrev_b32 v70, 16, v105
    v_and_b32 v71, 0xffff0000, v105
    v_add_f32 v66, v66, v70
    v_add_f32 v67, v67, v71
    v_lshlrev_b32 v72, 16, v106
    v_and_b32 v73, 0xffff0000, v106
    v_add_f32 v64, v64, v72
    v_add_f32 v65, v65, v73
    v_lshlrev_b32 v74, 16, v107
    v_and_b32 v75, 0xffff0000, v107
    v_add_f32 v66, v66, v74
    v_add_f32 v67, v67, v75
    v_lshlrev_b32 v68, 16, v108
    v_and_b32 v69, 0xffff0000, v108
    v_add_f32 v64, v64, v68
    v_add_f32 v65, v65, v69
    v_lshlrev_b32 v70, 16, v109
    v_and_b32 v71, 0xffff0000, v109
    v_add_f32 v66, v66, v70
    v_add_f32 v67, v67, v71
    v_lshlrev_b32 v72, 16, v110
    v_and_b32 v73, 0xffff0000, v110
    v_add_f32 v64, v64, v72
    v_add_f32 v65, v65, v73
    v_lshlrev_b32 v74, 16, v111
    v_and_b32 v75, 0xffff0000, v111
    v_add_f32 v66, v66, v74
    v_add_f32 v67, v67, v75
    v_lshlrev_b32 v68, 16, v112
    v_and_b32 v69, 0xffff0000, v112
    v_add_f32 v64, v64, v68
    v_add_f32 v65, v65, v69
    v_lshlrev_b32 v70, 16, v113
    v_and_b32 v71, 0xffff0000, v113
    v_add_f32 v66, v66, v70
    v_add_f32 v67, v67, v71
    v_lshlrev_b32 v72, 16, v114
    v_and_b32 v73, 0xffff0000, v114
    v_add_f32 v64, v64, v72
    v_add_f32 v65, v65, v73
    v_lshlrev_b32 v74, 16, v115
    v_and_b32 v75, 0xffff0000, v115
    v_add_f32 v66, v66, v74
    v_add_f32 v67, v67, v75
    v_lshlrev_b32 v68, 16, v116
    v_and_b32 v69, 0xffff0000, v116
    v_add_f32 v64, v64, v68
    v_add_f32 v65, v65, v69
    v_lshlrev_b32 v70, 16, v117
    v_and_b32 v71, 0xffff0000, v117
    v_add_f32 v66, v66, v70
    v_add_f32 v67, v67, v71
    v_lshlrev_b32 v72, 16, v118
    v_and_b32 v73, 0xffff0000, v118
    v_add_f32 v64, v64, v72
    v_add_f32 v65, v65, v73
    v_lshlrev_b32 v74, 16, v119
    v_and_b32 v75, 0xffff0000, v119
    v_add_f32 v66, v66, v74
    v_add_f32 v67, v67, v75
    v_lshlrev_b32 v68, 16, v120
    v_and_b32 v69, 0xffff0000, v120
    v_add_f32 v64, v64, v68
    v_add_f32 v65, v65, v69
    v_lshlrev_b32 v70, 16, v121
    v_and_b32 v71, 0xffff0000, v121
    v_add_f32 v66, v66, v70
    v_add_f32 v67, v67, v71
    v_lshlrev_b32 v72, 16, v122
    v_and_b32 v73, 0xffff0000, v122
    v_add_f32 v64, v64, v72
    v_add_f32 v65, v65, v73
    v_lshlrev_b32 v74, 16, v123
    v_and_b32 v75, 0xffff0000, v123
    v_add_f32 v66, v66, v74
    v_add_f32 v67, v67, v75
    v_lshlrev_b32 v68, 16, v124
    v_and_b32 v69, 0xffff0000, v124
    v_add_f32 v64, v64, v68
    v_add_f32 v65, v65, v69
    v_lshlrev_b32 v70, 16, v125
    v_and_b32 v71, 0xffff0000, v125
    v_add_f32 v66, v66, v70
    v_add_f32 v67, v67, v71
    v_lshlrev_b32 v72, 16, v126
    v_and_b32 v73, 0xffff0000, v126
    v_add_f32 v64, v64, v72
    v_add_f32 v65, v65, v73
    v_lshlrev_b32 v74, 16, v127
    v_and_b32 v75, 0xffff0000, v127
    v_add_f32 v66, v66, v74
    v_add_f32 v67, v67, v75
    v_cvt_pk_bf16_f32 v8, v64, v65
    v_cvt_pk_bf16_f32 v9, v66, v67
    v_lshlrev_b32 v6, 3, v14
    v_add_u32 v6, 81920, v6
    ds_write_b64 v6, v[8:9]
    v_mov_b32 v6, 87040
    v_mov_b32 v7, 1
    s_waitcnt lgkmcnt(0)
    s_mov_b64 exec, 1
    ds_add_u32 v6, v7
    s_mov_b64 exec, -1
    v_max3_f32 v24, v44, v45, v46
    v_min3_f32 v25, v44, v45, v46
    v_max3_f32 v24, v24, v47, v48
    v_min3_f32 v25, v25, v47, v48
    v_max3_f32 v24, v24, v49, v50
    v_min3_f32 v25, v25, v49, v50
    v_max3_f32 v24, v24, v51, v52
    v_min3_f32 v25, v25, v51, v52
    v_max3_f32 v24, v24, v53, v54
    v_min3_f32 v25, v25, v53, v54
    v_max3_f32 v24, v24, v55, v56
    v_min3_f32 v25, v25, v55, v56
    v_max3_f32 v24, v24, v57, v58
    v_min3_f32 v25, v25, v57, v58
    v_max3_f32 v24, v24, v59, v60
    v_min3_f32 v25, v25, v59, v60
    v_max3_f32 v24, v24, v61, v62
    v_min3_f32 v25, v25, v61, v62
    v_max_f32 v24, v24, v63
    v_min_f32 v25, v25, v63
    v_mov_b32 v26, 0x3fb8aa3b
    v_mov_b32 v28, 0xbfb8aa3b
    v_mul_f32 v27, v28, v24
    v_mul_f32 v29, v26, v25
    v_fma_f32 v64, v44, v26, v27
    v_fma_f32 v84, v44, v28, v29
    v_fma_f32 v65, v45, v26, v27
    v_fma_f32 v85, v45, v28, v29
    v_fma_f32 v66, v46, v26, v27
    v_fma_f32 v86, v46, v28, v29
    v_fma_f32 v67, v47, v26, v27
    v_fma_f32 v87, v47, v28, v29
    v_fma_f32 v68, v48, v26, v27
    v_fma_f32 v88, v48, v28, v29
    v_fma_f32 v69, v49, v26, v27
    v_fma_f32 v89, v49, v28, v29
    v_fma_f32 v70, v50, v26, v27
    v_fma_f32 v90, v50, v28, v29
    v_fma_f32 v71, v51, v26, v27
    v_fma_f32 v91, v51, v28, v29
    v_fma_f32 v72, v52, v26, v27
    v_fma_f32 v92, v52, v28, v29
    v_fma_f32 v73, v53, v26, v27
    v_fma_f32 v93, v53, v28, v29
    v_fma_f32 v74, v54, v26, v27
    v_fma_f32 v94, v54, v28, v29
    v_fma_f32 v75, v55, v26, v27
    v_fma_f32 v95, v55, v28, v29
    v_fma_f32 v76, v56, v26, v27
    v_fma_f32 v96, v56, v28, v29
    v_fma_f32 v77, v57, v26, v27
    v_fma_f32 v97, v57, v28, v29
    v_fma_f32 v78, v58, v26, v27
    v_fma_f32 v98, v58, v28, v29
    v_fma_f32 v79, v59, v26, v27
    v_fma_f32 v99, v59, v28, v29
    v_fma_f32 v80, v60, v26, v27
    v_fma_f32 v100, v60, v28, v29
    v_fma_f32 v81, v61, v26, v27
    v_fma_f32 v101, v61, v28, v29
    v_fma_f32 v82, v62, v26, v27
    v_fma_f32 v102, v62, v28, v29
    v_fma_f32 v83, v63, v26, v27
    v_fma_f32 v103, v63, v28, v29
    v_exp_f32 v64, v64
    v_exp_f32 v65, v65
    v_exp_f32 v66, v66
    v_exp_f32 v67, v67
    v_exp_f32 v68, v68
    v_exp_f32 v69, v69
    v_exp_f32 v70, v70
    v_exp_f32 v71, v71
    v_exp_f32 v72, v72
    v_exp_f32 v73, v73
    v_exp_f32 v74, v74
    v_exp_f32 v75, v75
    v_exp_f32 v76, v76
    v_exp_f32 v77, v77
    v_exp_f32 v78, v78
    v_exp_f32 v79, v79
    v_exp_f32 v80, v80
    v_exp_f32 v81, v81
    v_exp_f32 v82, v82
    v_exp_f32 v83, v83
    v_exp_f32 v84, v84
    v_exp_f32 v85, v85
    v_exp_f32 v86, v86
    v_exp_f32 v87, v87
    v_exp_f32 v88, v88
    v_exp_f32 v89, v89
    v_exp_f32 v90, v90
    v_exp_f32 v91, v91
    v_exp_f32 v92, v92
    v_exp_f32 v93, v93
    v_exp_f32 v94, v94
    v_exp_f32 v95, v95
    v_exp_f32 v96, v96
    v_exp_f32 v97, v97
    v_exp_f32 v98, v98
    v_exp_f32 v99, v99
    v_exp_f32 v100, v100
    v_exp_f32 v101, v101
    v_exp_f32 v102, v102
    v_exp_f32 v103, v103
    s_nop 0
    v_add_f32 v24, v64, v65
    v_add_f32 v25, v66, v67
    v_add_f32 v24, v24, v68
    v_add_f32 v25, v25, v69
    v_add_f32 v24, v24, v70
    v_add_f32 v25, v25, v71
    v_add_f32 v24, v24, v72
    v_add_f32 v25, v25, v73
    v_add_f32 v24, v24, v74
    v_add_f32 v25, v25, v75
    v_add_f32 v24, v24, v76
    v_add_f32 v25, v25, v77
    v_add_f32 v24, v24, v78
    v_add_f32 v25, v25, v79
    v_add_f32 v24, v24, v80
    v_add_f32 v25, v25, v81
    v_add_f32 v24, v24, v82
    v_add_f32 v25, v25, v83
    v_add_f32 v24, v24, v25
    v_add_f32 v30, v84, v85
    v_add_f32 v31, v86, v87
    v_add_f32 v30, v30, v88
    v_add_f32 v31, v31, v89
    v_add_f32 v30, v30, v90
    v_add_f32 v31, v31, v91
    v_add_f32 v30, v30, v92
    v_add_f32 v31, v31, v93
    v_add_f32 v30, v30, v94
    v_add_f32 v31, v31, v95
    v_add_f32 v30, v30, v96
    v_add_f32 v31, v31, v97
    v_add_f32 v30, v30, v98
    v_add_f32 v31, v31, v99
    v_add_f32 v30, v30, v100
    v_add_f32 v31, v31, v101
    v_add_f32 v30, v30, v102
    v_add_f32 v31, v31, v103
    v_add_f32 v30, v30, v31
    v_rcp_f32 v24, v24
    v_rcp_f32 v30, v30
    s_nop 0
    v_mul_f32 v64, v64, v24
    v_mul_f32 v65, v65, v24
    v_cvt_pk_bf16_f32 v104, v64, v65
    v_mul_f32 v66, v66, v24
    v_mul_f32 v67, v67, v24
    v_cvt_pk_bf16_f32 v105, v66, v67
    v_mul_f32 v68, v68, v24
    v_mul_f32 v69, v69, v24
    v_cvt_pk_bf16_f32 v106, v68, v69
    v_mul_f32 v70, v70, v24
    v_mul_f32 v71, v71, v24
    v_cvt_pk_bf16_f32 v107, v70, v71
    v_mul_f32 v72, v72, v24
    v_mul_f32 v73, v73, v24
    v_cvt_pk_bf16_f32 v108, v72, v73
    v_mul_f32 v74, v74, v24
    v_mul_f32 v75, v75, v24
    v_cvt_pk_bf16_f32 v109, v74, v75
    v_mul_f32 v76, v76, v24
    v_mul_f32 v77, v77, v24
    v_cvt_pk_bf16_f32 v110, v76, v77
    v_mul_f32 v78, v78, v24
    v_mul_f32 v79, v79, v24
    v_cvt_pk_bf16_f32 v111, v78, v79
    v_mul_f32 v80, v80, v24
    v_mul_f32 v81, v81, v24
    v_cvt_pk_bf16_f32 v112, v80, v81
    v_mul_f32 v82, v82, v24
    v_mul_f32 v83, v83, v24
    v_cvt_pk_bf16_f32 v113, v82, v83
    v_mul_f32 v84, v84, v30
    v_mul_f32 v85, v85, v30
    v_cvt_pk_bf16_f32 v114, v84, v85
    v_mul_f32 v86, v86, v30
    v_mul_f32 v87, v87, v30
    v_cvt_pk_bf16_f32 v115, v86, v87
    v_mul_f32 v88, v88, v30
    v_mul_f32 v89, v89, v30
    v_cvt_pk_bf16_f32 v116, v88, v89
    v_mul_f32 v90, v90, v30
    v_mul_f32 v91, v91, v30
    v_cvt_pk_bf16_f32 v117, v90, v91
    v_mul_f32 v92, v92, v30
    v_mul_f32 v93, v93, v30
    v_cvt_pk_bf16_f32 v118, v92, v93
    v_mul_f32 v94, v94, v30
    v_mul_f32 v95, v95, v30
    v_cvt_pk_bf16_f32 v119, v94, v95
    v_mul_f32 v96, v96, v30
    v_mul_f32 v97, v97, v30
    v_cvt_pk_bf16_f32 v120, v96, v97
    v_mul_f32 v98, v98, v30
    v_mul_f32 v99, v99, v30
    v_cvt_pk_bf16_f32 v121, v98, v99
    v_mul_f32 v100, v100, v30
    v_mul_f32 v101, v101, v30
    v_cvt_pk_bf16_f32 v122, v100, v101
    v_mul_f32 v102, v102, v30
    v_mul_f32 v103, v103, v30
    v_cvt_pk_bf16_f32 v123, v102, v103
    v_mov_b32 v6, 87040
    s_mov_b32 s65, 4000000
K2_PSPIN:
    s_sub_u32 s65, s65, 1
    s_cbranch_scc1 K2_PSDONE
    ds_read_b32 v7, v6
    s_waitcnt lgkmcnt(0)
    v_readfirstlane_b32 s61, v7
    s_nop 3
    s_cmp_ge_u32 s61, 4
    s_cbranch_scc0 K2_PSPIN
K2_PSDONE:
    v_mul_u32_u24 v8, 80, v17
    v_add_u32 v8, 81920, v8
    v_mov_b32 v9, 84992
    v_cmp_eq_u32 vcc, v16, v2
    s_nop 1
    v_cndmask_b32 v8, v9, v8, vcc
    ds_read_b128 a[0:3], v8 offset:0
    ds_read_b128 a[20:23], v8 offset:320
    ds_read_b128 a[40:43], v8 offset:640
    ds_read_b128 a[60:63], v8 offset:960
    ds_read_b128 a[80:83], v8 offset:1280
    ds_read_b128 a[100:103], v8 offset:1600
    ds_read_b128 a[4:7], v8 offset:16
    ds_read_b128 a[24:27], v8 offset:336
    ds_read_b128 a[44:47], v8 offset:656
    ds_read_b128 a[64:67], v8 offset:976
    ds_read_b128 a[84:87], v8 offset:1296
    ds_read_b128 a[104:107], v8 offset:1616
    ds_read_b128 a[8:11], v8 offset:32
    ds_read_b128 a[28:31], v8 offset:352
    ds_read_b128 a[48:51], v8 offset:672
    ds_read_b128 a[68:71], v8 offset:992
    ds_read_b128 a[88:91], v8 offset:1312
    ds_read_b128 a[108:111], v8 offset:1632
    ds_read_b128 a[12:15], v8 offset:48
    ds_read_b128 a[32:35], v8 offset:368
    ds_read_b128 a[52:55], v8 offset:688
    ds_read_b128 a[72:75], v8 offset:1008
    ds_read_b128 a[92:95], v8 offset:1328
    ds_read_b128 a[112:115], v8 offset:1648
    ds_read_b128 a[16:19], v8 offset:64
    ds_read_b128 a[36:39], v8 offset:384
    ds_read_b128 a[56:59], v8 offset:704
    ds_read_b128 a[76:79], v8 offset:1024
    ds_read_b128 a[96:99], v8 offset:1344
    ds_read_b128 a[116:119], v8 offset:1664
    s_waitcnt lgkmcnt(15)
    s_nop 7
    v_mfma_f32_16x16x32_bf16 v[64:67], a[0:3], v[104:107], 0
    v_mfma_f32_16x16x32_bf16 v[68:71], a[20:23], v[104:107], 0
    v_mfma_f32_16x16x32_bf16 v[72:75], a[40:43], v[104:107], 0
    v_mfma_f32_16x16x32_bf16 v[76:79], a[60:63], v[104:107], 0
    v_mfma_f32_16x16x32_bf16 v[80:83], a[80:83], v[104:107], 0
    v_mfma_f32_16x16x32_bf16 v[84:87], a[100:103], v[104:107], 0
    s_waitcnt lgkmcnt(15)
    s_nop 7
    v_mfma_f32_16x16x32_bf16 v[64:67], a[4:7], v[108:111], v[64:67]
    v_mfma_f32_16x16x32_bf16 v[68:71], a[24:27], v[108:111], v[68:71]
    v_mfma_f32_16x16x32_bf16 v[72:75], a[44:47], v[108:111], v[72:75]
    v_mfma_f32_16x16x32_bf16 v[76:79], a[64:67], v[108:111], v[76:79]
    v_mfma_f32_16x16x32_bf16 v[80:83], a[84:87], v[108:111], v[80:83]
    v_mfma_f32_16x16x32_bf16 v[84:87], a[104:107], v[108:111], v[84:87]
    s_waitcnt lgkmcnt(12)
    s_nop 7
    v_mfma_f32_16x16x32_bf16 v[64:67], a[8:11], v[112:115], v[64:67]
    v_mfma_f32_16x16x32_bf16 v[68:71], a[28:31], v[112:115], v[68:71]
    v_mfma_f32_16x16x32_bf16 v[72:75], a[48:51], v[112:115], v[72:75]
    v_mfma_f32_16x16x32_bf16 v[76:79], a[68:71], v[112:115], v[76:79]
    v_mfma_f32_16x16x32_bf16 v[80:83], a[88:91], v[112:115], v[80:83]
    v_mfma_f32_16x16x32_bf16 v[84:87], a[108:111], v[112:115], v[84:87]
    s_waitcnt lgkmcnt(6)
    s_nop 7
    v_mfma_f32_16x16x32_bf16 v[64:67], a[12:15], v[116:119], v[64:67]
    v_mfma_f32_16x16x32_bf16 v[68:71], a[32:35], v[116:119], v[68:71]
    v_mfma_f32_16x16x32_bf16 v[72:75], a[52:55], v[116:119], v[72:75]
    v_mfma_f32_16x16x32_bf16 v[76:79], a[72:75], v[116:119], v[76:79]
    v_mfma_f32_16x16x32_bf16 v[80:83], a[92:95], v[116:119], v[80:83]
    v_mfma_f32_16x16x32_bf16 v[84:87], a[112:115], v[116:119], v[84:87]
    s_waitcnt lgkmcnt(0)
    s_nop 7
    v_mfma_f32_16x16x32_bf16 v[64:67], a[16:19], v[120:123], v[64:67]
    v_mfma_f32_16x16x32_bf16 v[68:71], a[36:39], v[120:123], v[68:71]
    v_mfma_f32_16x16x32_bf16 v[72:75], a[56:59], v[120:123], v[72:75]
    v_mfma_f32_16x16x32_bf16 v[76:79], a[76:79], v[120:123], v[76:79]
    v_mfma_f32_16x16x32_bf16 v[80:83], a[96:99], v[120:123], v[80:83]
    v_mfma_f32_16x16x32_bf16 v[84:87], a[116:119], v[120:123], v[84:87]
    s_nop 7
    s_nop 1
    v_add_f32 v12, 0x358637bd, v84
    v_rcp_f32 v12, v12
    s_nop 0
    v_mul_f32 v64, v64, v12
    v_mul_f32 v65, v65, v12
    v_cvt_pk_bf16_f32 v88, v64, v65
    v_mul_f32 v66, v66, v12
    v_mul_f32 v67, v67, v12
    v_cvt_pk_bf16_f32 v89, v66, v67
    v_mul_f32 v68, v68, v12
    v_mul_f32 v69, v69, v12
    v_cvt_pk_bf16_f32 v90, v68, v69
    v_mul_f32 v70, v70, v12
    v_mul_f32 v71, v71, v12
    v_cvt_pk_bf16_f32 v91, v70, v71
    v_mul_f32 v72, v72, v12
    v_mul_f32 v73, v73, v12
    v_cvt_pk_bf16_f32 v92, v72, v73
    v_mul_f32 v74, v74, v12
    v_mul_f32 v75, v75, v12
    v_cvt_pk_bf16_f32 v93, v74, v75
    v_mul_f32 v76, v76, v12
    v_mul_f32 v77, v77, v12
    v_cvt_pk_bf16_f32 v94, v76, v77
    v_mul_f32 v78, v78, v12
    v_mul_f32 v79, v79, v12
    v_cvt_pk_bf16_f32 v95, v78, v79
    v_mul_f32 v80, v80, v12
    v_mul_f32 v81, v81, v12
    v_cvt_pk_bf16_f32 v96, v80, v81
    v_mul_f32 v82, v82, v12
    v_mul_f32 v83, v83, v12
    v_cvt_pk_bf16_f32 v97, v82, v83
    v_lshlrev_b32 v6, 10, v2
    v_lshl_add_u32 v6, v3, 4, v6
    s_lshl_b32 s50, s48, 2
    s_add_u32 s50, s50, s49
    s_mul_i32 s50, s50, 20
    s_mul_i32 s51, s47, 5
    v_lshlrev_b32 v6, 10, v2
    v_lshl_add_u32 v6, v3, 3, v6
    s_add_u32 s52, s51, 0
    s_lshr_b32 s53, s52, 3
    s_add_u32 s53, s53, s50
    s_lshl_b32 s53, s53, 12
    s_and_b32 s61, s52, 6
    s_lshl_b32 s61, s61, 6
    s_add_u32 s53, s53, s61
    s_and_b32 s61, s52, 1
    s_lshl_b32 s61, s61, 9
    s_add_u32 s53, s53, s61
    s_add_u32 s53, s53, 13647872
    buffer_store_dwordx2 v[88:89], v6, s[24:27], s53 offen sc1
    s_add_u32 s52, s51, 1
    s_lshr_b32 s53, s52, 3
    s_add_u32 s53, s53, s50
    s_lshl_b32 s53, s53, 12
    s_and_b32 s61, s52, 6
    s_lshl_b32 s61, s61, 6
    s_add_u32 s53, s53, s61
    s_and_b32 s61, s52, 1
    s_lshl_b32 s61, s61, 9
    s_add_u32 s53, s53, s61
    s_add_u32 s53, s53, 13647872
    buffer_store_dwordx2 v[90:91], v6, s[24:27], s53 offen sc1
    s_add_u32 s52, s51, 2
    s_lshr_b32 s53, s52, 3
    s_add_u32 s53, s53, s50
    s_lshl_b32 s53, s53, 12
    s_and_b32 s61, s52, 6
    s_lshl_b32 s61, s61, 6
    s_add_u32 s53, s53, s61
    s_and_b32 s61, s52, 1
    s_lshl_b32 s61, s61, 9
    s_add_u32 s53, s53, s61
    s_add_u32 s53, s53, 13647872
    buffer_store_dwordx2 v[92:93], v6, s[24:27], s53 offen sc1
    s_add_u32 s52, s51, 3
    s_lshr_b32 s53, s52, 3
    s_add_u32 s53, s53, s50
    s_lshl_b32 s53, s53, 12
    s_and_b32 s61, s52, 6
    s_lshl_b32 s61, s61, 6
    s_add_u32 s53, s53, s61
    s_and_b32 s61, s52, 1
    s_lshl_b32 s61, s61, 9
    s_add_u32 s53, s53, s61
    s_add_u32 s53, s53, 13647872
    buffer_store_dwordx2 v[94:95], v6, s[24:27], s53 offen sc1
    s_add_u32 s52, s51, 4
    s_lshr_b32 s53, s52, 3
    s_add_u32 s53, s53, s50
    s_lshl_b32 s53, s53, 12
    s_and_b32 s61, s52, 6
    s_lshl_b32 s61, s61, 6
    s_add_u32 s53, s53, s61
    s_and_b32 s61, s52, 1
    s_lshl_b32 s61, s61, 9
    s_add_u32 s53, s53, s61
    s_add_u32 s53, s53, 13647872
    buffer_store_dwordx2 v[96:97], v6, s[24:27], s53 offen sc1
    s_waitcnt vmcnt(0)
    v_mov_b32 v6, 87044
    v_mov_b32 v7, 1
    s_mov_b64 exec, 1
    ds_add_rtn_u32 v8, v6, v7
    s_waitcnt lgkmcnt(0)
    v_readfirstlane_b32 s61, v8
    s_nop 3
    s_cmp_eq_u32 s61, 3
    s_cbranch_scc0 K2_NOSIG
    s_lshl_b32 s50, s48, 7
    s_lshl_b32 s51, s47, 2
    s_add_u32 s50, s50, s51
    s_add_u32 s50, s50, 16269312
    v_mov_b32 v6, 0
    buffer_store_dword v7, v6, s[24:27], s50 offen sc1
K2_NOSIG:
    s_mov_b64 exec, -1
K2_END:
K2_EXIT:
    s_endpgm
HH_CODE_END:
    s_endpgm
.section .rodata,"a"
.p2align 6
.amdhsa_kernel hh1_kernel
  .amdhsa_next_free_vgpr 256
  .amdhsa_next_free_sgpr 102
  .amdhsa_accum_offset 256
  .amdhsa_group_segment_fixed_size 0
  .amdhsa_kernarg_size 80
  .amdhsa_user_sgpr_count 2
  .amdhsa_user_sgpr_kernarg_segment_ptr 1
  .amdhsa_system_sgpr_workgroup_id_x 1
.end_amdhsa_kernel
.p2align 6
.amdhsa_kernel hh2_kernel
  .amdhsa_next_free_vgpr 256
  .amdhsa_next_free_sgpr 102
  .amdhsa_accum_offset 128
  .amdhsa_group_segment_fixed_size 0
  .amdhsa_kernarg_size 80
  .amdhsa_user_sgpr_count 2
  .amdhsa_user_sgpr_kernarg_segment_ptr 1
  .amdhsa_system_sgpr_workgroup_id_x 1
.end_amdhsa_kernel
```
